```python
import torch

def _softmax(x, axis=-1):
    return torch.softmax(x, dim=axis)
def _gelu(x):
    return torch.nn.functional.gelu(x, approximate="tanh")
def _silu(x):
    return torch.nn.functional.silu(x)
def _sigmoid(x):
    return torch.sigmoid(x)
def _layernorm(x, axis=-1, eps=1e-5):
    m = x.mean(dim=axis, keepdim=True)
    v = x.var(dim=axis, keepdim=True, unbiased=False)
    return (x - m) / torch.sqrt(v + eps)
def _scatter_add(tgt, idx, src, axis=0):
    return tgt.clone().index_add_(axis, idx, src)
def _segment_sum(src, seg, n):
    out = torch.zeros((n,) + src.shape[1:], dtype=src.dtype)
    return out.index_add_(0, seg, src)
def _pad(x, pw):
    flat = tuple(v for pair in reversed(pw) for v in pair)
    return torch.nn.functional.pad(x, flat)

kernel_name = 'gated_mix__ssm_conv_s5__ssm_conv_s4__prompt'

def setup_inputs():

    _w = (lambda a: (lambda t: t.to(torch.bfloat16) if t.is_floating_point() else t)(torch.as_tensor(a)))
    def _A_setup():
        B, S, D = 1, 2048, 512
        P = D
        Lambda_re = -0.5 * (lambda _x: torch.exp(torch.as_tensor(_x)))((lambda *s: torch.randn(*s, dtype=torch.bfloat16) * 0.2)(P))
        Lambda_im = (lambda *s: torch.randn(*s, dtype=torch.bfloat16) * 0.4)(P) * 1.0
        B_re = (lambda *s: torch.randn(*s, dtype=torch.bfloat16) * 0.2)(P, D) * (D ** -0.5)
        B_im = (lambda *s: torch.randn(*s, dtype=torch.bfloat16) * 0.2)(P, D) * (D ** -0.5)
        C_re = (lambda *s: torch.randn(*s, dtype=torch.bfloat16) * 0.2)(D, P) * (P ** -0.5)
        C_im = (lambda *s: torch.randn(*s, dtype=torch.bfloat16) * 0.2)(D, P) * (P ** -0.5)
        log_dt = (lambda *s: torch.randn(*s, dtype=torch.bfloat16) * 0.2)(P) * 0.3 - 2.0
        Dskip = (lambda *s: torch.randn(*s, dtype=torch.bfloat16) * 0.05)(D)
        return {
            "x": _w((lambda *s: torch.randn(*s, dtype=torch.bfloat16) * 0.05)(B, S, D)),
            "Lambda_re": _w(Lambda_re),
            "Lambda_im": _w(Lambda_im),
            "B_re": _w(B_re),
            "B_im": _w(B_im),
            "C_re": _w(C_re),
            "C_im": _w(C_im),
            "log_dt": _w(log_dt),
            "Dskip": _w(Dskip),
        }
    _A_in = _A_setup()

    def _B_setup():
        B, L, D, N = 1, 2048, 512, 128
        A_re = -(lambda _x: torch.exp(torch.as_tensor(_x)))((lambda *s: torch.randn(*s, dtype=torch.bfloat16) * 3.2)(D, N))
        A_im = torch.pi * (lambda *s: torch.randn(*s, dtype=torch.bfloat16) * 0.05)(D, N)
        B_re = (lambda *s: torch.randn(*s, dtype=torch.bfloat16) * 0.1)(D, N)
        B_im = (lambda *s: torch.randn(*s, dtype=torch.bfloat16) * 0.1)(D, N)
        C_re = (lambda *s: torch.randn(*s, dtype=torch.bfloat16) * 0.1)(D, N)
        C_im = (lambda *s: torch.randn(*s, dtype=torch.bfloat16) * 0.1)(D, N)
        log_dt = (lambda *s: torch.randn(*s, dtype=torch.bfloat16) * 0.05)(D) * 0.5 - 4.0
        Dskip = (lambda *s: torch.randn(*s, dtype=torch.bfloat16) * 0.05)(D)
        return {
            "u": _w((lambda *s: torch.randn(*s, dtype=torch.bfloat16) * 0.05)(B, L, D)),
            "A_re": _w(A_re),
            "A_im": _w(A_im),
            "B_re": _w(B_re),
            "B_im": _w(B_im),
            "C_re": _w(C_re),
            "C_im": _w(C_im),
            "log_dt": _w(log_dt),
            "Dskip": _w(Dskip),
        }
    _B_in = _B_setup()

    return {
        "A_x": _A_in["x"],
        "A_Lambda_re": _A_in["Lambda_re"],
        "A_Lambda_im": _A_in["Lambda_im"],
        "A_B_re": _A_in["B_re"],
        "A_B_im": _A_in["B_im"],
        "A_C_re": _A_in["C_re"],
        "A_C_im": _A_in["C_im"],
        "A_log_dt": _A_in["log_dt"],
        "A_Dskip": _A_in["Dskip"],
        "B_u": _B_in["u"],
        "B_A_re": _B_in["A_re"],
        "B_A_im": _B_in["A_im"],
        "B_B_re": _B_in["B_re"],
        "B_B_im": _B_in["B_im"],
        "B_C_re": _B_in["C_re"],
        "B_C_im": _B_in["C_im"],
        "B_log_dt": _B_in["log_dt"],
        "B_Dskip": _B_in["Dskip"],
        "gate_w": _w((lambda *s: torch.randn(*s, dtype=torch.bfloat16) * 0.05)(512) * 16.0),
    }

def reference(A_x, A_Lambda_re, A_Lambda_im, A_B_re, A_B_im, A_C_re, A_C_im, A_log_dt, A_Dskip, B_u, B_A_re, B_A_im, B_B_re, B_B_im, B_C_re, B_C_im, B_log_dt, B_Dskip, gate_w):
    def _A_ref(x, Lambda_re, Lambda_im, B_re, B_im, C_re, C_im, log_dt, Dskip):
        Bsz, L, H = x.shape
        Lam = Lambda_re + 1j * Lambda_im
        Bmat = B_re + 1j * B_im
        Cmat = C_re + 1j * C_im
        dt = torch.exp(log_dt)
        Lam_bar = torch.exp(dt * Lam)
        B_bar = ((Lam_bar - 1.0) / Lam)[:, None] * Bmat
        Bu = torch.einsum("bld,pd->blp", x + 0j, B_bar)
        h = torch.zeros_like(Bu[:, 0, :])
        hs = []
        for t in range(L):
            h = Lam_bar[None, :] * h + Bu[:, t, :]
            hs.append(h)
        hseq = torch.stack(hs, 1)
        y = 2.0 * torch.einsum("blp,dp->bld", hseq, Cmat).real + x * Dskip[None, None, :]
        return y

    def _B_ref(u, A_re, A_im, B_re, B_im, C_re, C_im, log_dt, Dskip):
        Bsz, L, D = u.shape
        dt = torch.exp(log_dt)[:, None]
        A = A_re + 1j * A_im
        Bc = B_re + 1j * B_im
        Cc = C_re + 1j * C_im
        logdA = dt * A
        dB = dt * Bc
        l = (lambda x, dt: x.to(dt))(torch.arange(L), A_re.dtype)
        P = torch.exp(logdA[:, :, None] * l[None, None, :])
        K = torch.einsum("dn,dnl,dn->dl", Cc, P, dB).real
        L2 = 2 * L
        Kp = _pad(K, ((0, 0), (0, L)))
        up = (lambda x, *d: x.permute(*d))(u, 0, 2, 1)
        up = _pad(up, ((0, 0), (0, 0), (0, L)))
        Kf = (lambda x, axes=(-2,-1): torch.fft.rfft2(x.float(), dim=axes))(Kp[:, None, :], axes=(-2, -1))
        Uf = (lambda x, axes=(-2,-1): torch.fft.rfft2(x.float(), dim=axes))(up[:, :, None, :], axes=(-2, -1))
        Yf = Uf * Kf[None, :, :, :]
        y = (lambda x, s, axes=(-2,-1): torch.fft.irfft2(x, s=s, dim=axes).to(torch.bfloat16))(Yf, (1, L2), axes=(-2, -1))[:, :, 0, :L]
        y = (lambda x, *d: x.permute(*d))(y, 0, 2, 1) + u * Dskip[None, None, :]
        return y

    x = A_x
    g = _sigmoid((x * gate_w).sum(-1, keepdims=True))
    a = _A_ref(x, A_Lambda_re, A_Lambda_im, A_B_re, A_B_im, A_C_re, A_C_im, A_log_dt, A_Dskip)
    b = _B_ref(x, B_A_re, B_A_im, B_B_re, B_B_im, B_C_re, B_C_im, B_log_dt, B_Dskip)
    return g * a + (1 - g) * b
```

```asm
; @launch kernel=mix_a_kernel grid=(256,1,1) block=(512,1,1) lds=156288
; @launch kernel=mix_b_kernel grid=(256,1,1) block=(512,1,1) lds=163840
.amdgcn_target "amdgcn-amd-amdhsa--gfx950"
.text
.globl mix_a_kernel
.p2align 8
.type mix_a_kernel,@function
mix_a_kernel:
    s_load_dwordx16 s[8:23], s[0:1], 0
    s_load_dwordx16 s[24:39], s[0:1], 64
    s_load_dwordx8 s[40:47], s[0:1], 128
    s_load_dwordx4 s[48:51], s[0:1], 160
    s_cmp_ge_u32 s2, 256
    s_cbranch_scc1 L_end1
    s_and_b32 s3, s2, 7
    s_lshr_b32 s4, s2, 3
    s_cmp_ge_u32 s4, 16
    s_cbranch_scc1 L_conv
    s_lshl_b32 s3, s3, 1
    s_lshr_b32 s5, s4, 3
    s_add_u32 s3, s3, s5
    s_and_b32 s4, s4, 7
    v_and_b32 v1, 63, v0
    v_lshrrev_b32 v2, 6, v0
    s_nop 0
    v_readfirstlane_b32 s5, v2
    v_lshrrev_b32 v6, 5, v1
    v_bfe_u32 v7, v1, 3, 2
    v_lshl_add_u32 v7, v6, 4, v7
    v_lshlrev_b32 v7, 10, v7
    v_lshrrev_b32 v8, 4, v1
    v_and_b32 v9, 7, v1
    v_xor_b32 v8, v8, v9
    v_lshl_or_b32 v2, v8, 4, v7
    v_xor_b32 v3, 64, v2
    v_add_u32 v3, 0x1000, v3
    v_add_u32 v4, 0x2000, v2
    v_add_u32 v5, 0x2000, v3
    s_and_b32 s6, s5, 3
    s_lshr_b32 s7, s5, 2
    s_lshl_b32 s60, s4, 7
    v_bfe_u32 v16, v1, 2, 1
    v_bfe_u32 v17, v1, 3, 2
    v_and_b32 v18, 3, v1
    v_lshl_add_u32 v18, v16, 4, v18
    v_lshl_add_u32 v18, v17, 2, v18
    s_lshl_b32 s69, s7, 5
    v_add_u32 v19, s69, v18
    v_lshl_add_u32 v10, v19, 1, s60
    s_lshl_b32 s62, s3, 7
    s_lshl_b32 s63, s4, 4
    s_add_u32 s62, s62, s63
    s_lshl_b32 s63, s5, 1
    s_add_u32 s62, s62, s63
    s_lshl_b32 s63, s62, 10
    v_lshlrev_b32 v14, 4, v1
    v_add_u32 v15, s63, v14
    s_and_b32 s76, s3, 1
    s_lshl_b32 s76, s76, 2
    s_add_u32 s76, s76, s4
    s_lshl_b32 s76, s76, 7
    s_lshr_b32 s64, s5, 1
    s_add_u32 s64, s64, 1
    s_lshl_b32 s64, s64, 7
    s_add_u32 s64, s64, s76
    s_and_b32 s64, s64, 0x380
    s_lshl_b32 s65, s4, 16
    s_add_u32 s64, s64, s65
    v_lshl_add_u32 v249, v1, 10, s64
    s_waitcnt lgkmcnt(0)
    s_bitcmp1_b32 s5, 0
    s_cselect_b64 s[52:53], s[16:17], s[14:15]
    s_lshl_b32 s64, s4, 6
    s_lshr_b32 s65, s6, 1
    s_lshl_b32 s65, s65, 5
    s_add_u32 s64, s64, s65
    s_lshl_b32 s65, s3, 7
    s_lshl_b32 s66, s6, 5
    s_add_u32 s65, s65, s66
    s_mov_b32 s54, 0x80000
    s_cmp_eq_u32 s7, 0
    s_cselect_b64 s[52:53], s[8:9], s[52:53]
    s_cselect_b32 s54, 0x200000, s54
    s_cselect_b32 s64, s65, s64
    s_mov_b32 s55, 0x00020000
    s_lshl_b32 s64, s64, 10
    s_lshl_b32 s66, s5, 12
    s_add_u32 s65, s76, 0
    s_and_b32 s65, s65, 0x380
    s_add_u32 s65, s65, s64
    s_add_u32 m0, s66, 0
    s_nop 0
    buffer_load_dwordx4 v2, s[52:55], s65 offen lds
    s_add_u32 m0, s66, 1024
    s_nop 0
    buffer_load_dwordx4 v3, s[52:55], s65 offen lds
    s_add_u32 m0, s66, 2048
    s_nop 0
    buffer_load_dwordx4 v4, s[52:55], s65 offen lds
    s_add_u32 m0, s66, 3072
    s_nop 0
    buffer_load_dwordx4 v5, s[52:55], s65 offen lds
    s_barrier
    s_add_u32 s65, s76, 128
    s_and_b32 s65, s65, 0x380
    s_add_u32 s65, s65, s64
    s_add_u32 m0, s66, 32768
    s_nop 0
    buffer_load_dwordx4 v2, s[52:55], s65 offen lds
    s_add_u32 m0, s66, 33792
    s_nop 0
    buffer_load_dwordx4 v3, s[52:55], s65 offen lds
    s_add_u32 m0, s66, 34816
    s_nop 0
    buffer_load_dwordx4 v4, s[52:55], s65 offen lds
    s_add_u32 m0, s66, 35840
    s_nop 0
    buffer_load_dwordx4 v5, s[52:55], s65 offen lds
    global_load_ushort v20, v10, s[10:11]
    global_load_ushort v21, v10, s[12:13]
    global_load_ushort v22, v10, s[22:23]
    global_load_dwordx4 v[28:31], v14, s[44:45]
    global_load_dwordx4 v[32:35], v15, s[8:9]
    global_load_dwordx4 v[36:39], v15, s[8:9] offset:1024
    s_mov_b32 s56, s50
    s_mov_b32 s57, s51
    s_mov_b32 s58, 0x1000000
    s_mov_b32 s59, 0x00020000
    v_mov_b32 v16, 0
    v_mov_b32 v17, 0
    v_lshlrev_b32 v18, 3, v0
    v_add_u32 v18, 0x20000, v18
    ds_write_b64 v18, v[16:17]
    v_and_b32 v16, 31, v1
    v_bfe_u32 v17, v1, 1, 3
    v_xor_b32 v17, v17, v6
    v_lshlrev_b32 v16, 7, v16
    v_lshl_or_b32 v16, v17, 4, v16
    s_lshl_b32 s67, s6, 12
    s_lshl_b32 s68, s7, 13
    s_add_u32 s68, s68, 0x4000
    v_xor_b32 v17, 0, v16
    v_add_u32 v40, s67, v17
    v_add_u32 v44, s68, v17
    v_xor_b32 v17, 32, v16
    v_add_u32 v41, s67, v17
    v_add_u32 v45, s68, v17
    v_xor_b32 v17, 64, v16
    v_add_u32 v42, s67, v17
    v_add_u32 v46, s68, v17
    v_xor_b32 v17, 96, v16
    v_add_u32 v43, s67, v17
    v_add_u32 v47, s68, v17
    s_waitcnt lgkmcnt(0)
    s_waitcnt vmcnt(10)
    s_barrier
    ds_read_b128 v[96:99], v40 offset:0
    ds_read_b128 v[100:103], v44 offset:0
    ds_read_b128 v[104:107], v44 offset:4096
    ds_read_b128 v[108:111], v41 offset:0
    ds_read_b128 v[112:115], v45 offset:0
    ds_read_b128 v[116:119], v45 offset:4096
    ds_read_b128 v[120:123], v42 offset:0
    ds_read_b128 v[124:127], v46 offset:0
    ds_read_b128 v[128:131], v46 offset:4096
    ds_read_b128 v[132:135], v43 offset:0
    ds_read_b128 v[136:139], v47 offset:0
    ds_read_b128 v[140:143], v47 offset:4096
    s_waitcnt lgkmcnt(9)
    v_mfma_f32_32x32x16_bf16 v[64:79], v[96:99], v[100:103], 0
    s_add_u32 s65, s76, 256
    s_and_b32 s65, s65, 0x380
    s_add_u32 s65, s65, s64
    s_add_u32 m0, s66, 65536
    s_nop 0
    buffer_load_dwordx4 v2, s[52:55], s65 offen lds
    v_mfma_f32_32x32x16_bf16 v[80:95], v[96:99], v[104:107], 0
    s_add_u32 m0, s66, 66560
    s_nop 0
    buffer_load_dwordx4 v3, s[52:55], s65 offen lds
    s_waitcnt vmcnt(8)
    s_barrier
    s_waitcnt lgkmcnt(6)
    v_mfma_f32_32x32x16_bf16 v[64:79], v[108:111], v[112:115], v[64:79]
    ds_read_b128 v[144:147], v40 offset:32768
    ds_read_b128 v[148:151], v44 offset:32768
    s_add_u32 m0, s66, 67584
    s_nop 0
    buffer_load_dwordx4 v4, s[52:55], s65 offen lds
    v_mfma_f32_32x32x16_bf16 v[80:95], v[108:111], v[116:119], v[80:95]
    ds_read_b128 v[152:155], v44 offset:36864
    ds_read_b128 v[156:159], v41 offset:32768
    s_add_u32 m0, s66, 68608
    s_nop 0
    buffer_load_dwordx4 v5, s[52:55], s65 offen lds
    s_waitcnt lgkmcnt(7)
    v_mfma_f32_32x32x16_bf16 v[64:79], v[120:123], v[124:127], v[64:79]
    ds_read_b128 v[160:163], v45 offset:32768
    ds_read_b128 v[164:167], v45 offset:36864
    s_add_u32 s65, s76, 384
    s_and_b32 s65, s65, 0x380
    s_add_u32 s65, s65, s64
    s_add_u32 m0, s66, 98304
    s_nop 0
    buffer_load_dwordx4 v2, s[52:55], s65 offen lds
    v_mfma_f32_32x32x16_bf16 v[80:95], v[120:123], v[128:131], v[80:95]
    ds_read_b128 v[168:171], v42 offset:32768
    ds_read_b128 v[172:175], v46 offset:32768
    s_add_u32 m0, s66, 99328
    s_nop 0
    buffer_load_dwordx4 v3, s[52:55], s65 offen lds
    s_waitcnt lgkmcnt(8)
    v_mfma_f32_32x32x16_bf16 v[64:79], v[132:135], v[136:139], v[64:79]
    ds_read_b128 v[176:179], v46 offset:36864
    ds_read_b128 v[180:183], v43 offset:32768
    s_add_u32 m0, s66, 100352
    s_nop 0
    buffer_load_dwordx4 v4, s[52:55], s65 offen lds
    v_mfma_f32_32x32x16_bf16 v[80:95], v[132:135], v[140:143], v[80:95]
    ds_read_b128 v[184:187], v47 offset:32768
    ds_read_b128 v[188:191], v47 offset:36864
    s_add_u32 m0, s66, 101376
    s_nop 0
    buffer_load_dwordx4 v5, s[52:55], s65 offen lds
    s_waitcnt lgkmcnt(9)
    v_mfma_f32_32x32x16_bf16 v[64:79], v[144:147], v[148:151], v[64:79]
    v_mfma_f32_32x32x16_bf16 v[80:95], v[144:147], v[152:155], v[80:95]
    v_xor_b32 v40, 0x10000, v40
    v_xor_b32 v41, 0x10000, v41
    v_xor_b32 v42, 0x10000, v42
    v_xor_b32 v43, 0x10000, v43
    v_xor_b32 v44, 0x10000, v44
    v_xor_b32 v45, 0x10000, v45
    v_xor_b32 v46, 0x10000, v46
    v_xor_b32 v47, 0x10000, v47
    s_waitcnt vmcnt(11)
    v_lshlrev_b32 v20, 16, v20
    v_lshlrev_b32 v21, 16, v21
    v_lshlrev_b32 v22, 16, v22
    v_mul_f32 v22, 0x3fb8aa3b, v22
    v_exp_f32 v22, v22
    s_nop 0
    v_cvt_pk_bf16_f32 v22, v22, v22
    v_lshlrev_b32 v22, 16, v22
    v_mul_f32 v48, v22, v20
    v_mul_f32 v49, v22, v21
    v_mul_f32 v48, 0x3fb8aa3b, v48
    v_mul_f32 v49, 0xbe22f983, v49
    v_exp_f32 v16, v48
    v_fract_f32 v17, v49
    v_cos_f32 v52, v17
    v_sin_f32 v53, v17
    v_mul_f32 v52, v52, v16
    v_mul_f32 v53, v53, v16
    v_mul_f32 v50, 0x41800000, v48
    v_mul_f32 v51, 0x41800000, v49
    v_exp_f32 v50, v50
    v_fract_f32 v51, v51
    v_cos_f32 v54, v51
    v_sin_f32 v55, v51
    v_mul_f32 v54, v54, v50
    v_mul_f32 v55, v55, v50
    v_mul_f32 v16, v20, v20
    v_fmac_f32 v16, v21, v21
    v_rcp_f32 v16, v16
    v_add_f32 v17, -1.0, v52
    v_mul_f32 v56, v17, v20
    v_mul_f32 v57, v17, v21
    v_fma_f32 v56, -v53, v21, v56
    v_fmac_f32 v57, v53, v20
    v_add_f32 v16, v16, v16
    v_mul_f32 v56, v56, v16
    v_mul_f32 v57, v57, v16
    s_waitcnt vmcnt(8)
    v_mov_b32 v62, 0
    v_mov_b32 v63, 0
    v_dot2c_f32_bf16 v62, v32, v28
    v_dot2c_f32_bf16 v63, v36, v28
    v_dot2c_f32_bf16 v62, v33, v29
    v_dot2c_f32_bf16 v63, v37, v29
    v_dot2c_f32_bf16 v62, v34, v30
    v_dot2c_f32_bf16 v63, v38, v30
    v_dot2c_f32_bf16 v62, v35, v31
    v_dot2c_f32_bf16 v63, v39, v31
    s_nop 1
    v_add_f32_dpp v62, v62, v62 row_shr:1 row_mask:0xf bank_mask:0xf bound_ctrl:0
    v_add_f32_dpp v63, v63, v63 row_shr:1 row_mask:0xf bank_mask:0xf bound_ctrl:0
    s_nop 0
    v_add_f32_dpp v62, v62, v62 row_shr:2 row_mask:0xf bank_mask:0xf bound_ctrl:0
    v_add_f32_dpp v63, v63, v63 row_shr:2 row_mask:0xf bank_mask:0xf bound_ctrl:0
    s_nop 0
    v_add_f32_dpp v62, v62, v62 row_shr:4 row_mask:0xf bank_mask:0xf bound_ctrl:0
    v_add_f32_dpp v63, v63, v63 row_shr:4 row_mask:0xf bank_mask:0xf bound_ctrl:0
    s_nop 0
    v_add_f32_dpp v62, v62, v62 row_shr:8 row_mask:0xf bank_mask:0xf bound_ctrl:0
    v_add_f32_dpp v63, v63, v63 row_shr:8 row_mask:0xf bank_mask:0xf bound_ctrl:0
    s_nop 0
    v_add_f32_dpp v62, v62, v62 row_bcast:15 row_mask:0xa bank_mask:0xf
    v_add_f32_dpp v63, v63, v63 row_bcast:15 row_mask:0xa bank_mask:0xf
    s_nop 0
    v_add_f32_dpp v62, v62, v62 row_bcast:31 row_mask:0xc bank_mask:0xf
    v_add_f32_dpp v63, v63, v63 row_bcast:31 row_mask:0xc bank_mask:0xf
    v_cvt_pk_bf16_f32 v62, v62, v63
    v_and_b32 v63, 0xffff0000, v62
    v_lshlrev_b32 v62, 16, v62
    v_mul_f32 v62, 0xbfb8aa3b, v62
    v_mul_f32 v63, 0xbfb8aa3b, v63
    v_exp_f32 v62, v62
    v_exp_f32 v63, v63
    v_add_f32 v62, 1.0, v62
    v_add_f32 v63, 1.0, v63
    v_rcp_f32 v62, v62
    v_rcp_f32 v63, v63
    s_nop 0
    v_cvt_pk_bf16_f32 v62, v62, v63
    v_and_b32 v63, 0xffff0000, v62
    v_lshlrev_b32 v62, 16, v62
    v_sub_f32 v28, 1.0, v62
    v_sub_f32 v29, 1.0, v63
    v_cvt_pk_bf16_f32 v62, v62, v28
    v_cvt_pk_bf16_f32 v63, v63, v29
    s_lshl_b32 s63, s62, 2
    s_add_u32 s63, s63, 0x410000
    v_mov_b32 v28, 0
    s_mov_b32 exec_lo, 0
    s_mov_b32 exec_hi, 0x80000000
    buffer_store_dwordx2 v[62:63], v28, s[56:59], s63 offen sc0 sc1
    s_mov_b64 exec, -1
    s_waitcnt vmcnt(5)
    s_barrier
    s_waitcnt lgkmcnt(6)
    v_mfma_f32_32x32x16_bf16 v[64:79], v[156:159], v[160:163], v[64:79]
    ds_read_b128 v[96:99], v40 offset:0
    ds_read_b128 v[100:103], v44 offset:0
    s_add_u32 s65, s76, 512
    s_and_b32 s65, s65, 0x380
    s_add_u32 s65, s65, s64
    s_add_u32 m0, s66, 0
    s_nop 0
    buffer_load_dwordx4 v2, s[52:55], s65 offen lds
    v_mfma_f32_32x32x16_bf16 v[80:95], v[156:159], v[164:167], v[80:95]
    ds_read_b128 v[104:107], v44 offset:4096
    ds_read_b128 v[108:111], v41 offset:0
    s_add_u32 m0, s66, 1024
    s_nop 0
    buffer_load_dwordx4 v3, s[52:55], s65 offen lds
    s_waitcnt lgkmcnt(7)
    v_mfma_f32_32x32x16_bf16 v[64:79], v[168:171], v[172:175], v[64:79]
    ds_read_b128 v[112:115], v45 offset:0
    ds_read_b128 v[116:119], v45 offset:4096
    s_add_u32 m0, s66, 2048
    s_nop 0
    buffer_load_dwordx4 v4, s[52:55], s65 offen lds
    v_mfma_f32_32x32x16_bf16 v[80:95], v[168:171], v[176:179], v[80:95]
    ds_read_b128 v[120:123], v42 offset:0
    ds_read_b128 v[124:127], v46 offset:0
    s_add_u32 m0, s66, 3072
    s_nop 0
    buffer_load_dwordx4 v5, s[52:55], s65 offen lds
    s_waitcnt lgkmcnt(8)
    v_mfma_f32_32x32x16_bf16 v[64:79], v[180:183], v[184:187], v[64:79]
    ds_read_b128 v[128:131], v46 offset:4096
    ds_read_b128 v[132:135], v43 offset:0
    v_mfma_f32_32x32x16_bf16 v[80:95], v[180:183], v[188:191], v[80:95]
    ds_read_b128 v[136:139], v47 offset:0
    ds_read_b128 v[140:143], v47 offset:4096
    s_waitcnt lgkmcnt(9)
    v_mfma_f32_32x32x16_bf16 v[64:79], v[96:99], v[100:103], v[64:79]
    v_mfma_f32_32x32x16_bf16 v[80:95], v[96:99], v[104:107], v[80:95]
    s_waitcnt vmcnt(5)
    s_barrier
    s_waitcnt lgkmcnt(6)
    v_mfma_f32_32x32x16_bf16 v[64:79], v[108:111], v[112:115], v[64:79]
    ds_read_b128 v[144:147], v40 offset:32768
    ds_read_b128 v[148:151], v44 offset:32768
    s_add_u32 s65, s76, 640
    s_and_b32 s65, s65, 0x380
    s_add_u32 s65, s65, s64
    s_add_u32 m0, s66, 32768
    s_nop 0
    buffer_load_dwordx4 v2, s[52:55], s65 offen lds
    v_mfma_f32_32x32x16_bf16 v[80:95], v[108:111], v[116:119], v[80:95]
    ds_read_b128 v[152:155], v44 offset:36864
    ds_read_b128 v[156:159], v41 offset:32768
    s_add_u32 m0, s66, 33792
    s_nop 0
    buffer_load_dwordx4 v3, s[52:55], s65 offen lds
    s_waitcnt lgkmcnt(7)
    v_mfma_f32_32x32x16_bf16 v[64:79], v[120:123], v[124:127], v[64:79]
    ds_read_b128 v[160:163], v45 offset:32768
    ds_read_b128 v[164:167], v45 offset:36864
    s_add_u32 m0, s66, 34816
    s_nop 0
    buffer_load_dwordx4 v4, s[52:55], s65 offen lds
    v_mfma_f32_32x32x16_bf16 v[80:95], v[120:123], v[128:131], v[80:95]
    ds_read_b128 v[168:171], v42 offset:32768
    ds_read_b128 v[172:175], v46 offset:32768
    s_add_u32 m0, s66, 35840
    s_nop 0
    buffer_load_dwordx4 v5, s[52:55], s65 offen lds
    s_waitcnt lgkmcnt(8)
    v_mfma_f32_32x32x16_bf16 v[64:79], v[132:135], v[136:139], v[64:79]
    ds_read_b128 v[176:179], v46 offset:36864
    ds_read_b128 v[180:183], v43 offset:32768
    v_mfma_f32_32x32x16_bf16 v[80:95], v[132:135], v[140:143], v[80:95]
    ds_read_b128 v[184:187], v47 offset:32768
    ds_read_b128 v[188:191], v47 offset:36864
    s_waitcnt lgkmcnt(9)
    v_mfma_f32_32x32x16_bf16 v[64:79], v[144:147], v[148:151], v[64:79]
    v_mfma_f32_32x32x16_bf16 v[80:95], v[144:147], v[152:155], v[80:95]
    v_xor_b32 v40, 0x10000, v40
    v_xor_b32 v41, 0x10000, v41
    v_xor_b32 v42, 0x10000, v42
    v_xor_b32 v43, 0x10000, v43
    v_xor_b32 v44, 0x10000, v44
    v_xor_b32 v45, 0x10000, v45
    v_xor_b32 v46, 0x10000, v46
    v_xor_b32 v47, 0x10000, v47
    s_waitcnt vmcnt(4)
    s_barrier
    s_waitcnt lgkmcnt(6)
    v_mfma_f32_32x32x16_bf16 v[64:79], v[156:159], v[160:163], v[64:79]
    ds_read_b128 v[96:99], v40 offset:0
    ds_read_b128 v[100:103], v44 offset:0
    s_add_u32 s65, s76, 768
    s_and_b32 s65, s65, 0x380
    s_add_u32 s65, s65, s64
    s_add_u32 m0, s66, 65536
    s_nop 0
    buffer_load_dwordx4 v2, s[52:55], s65 offen lds
    v_mfma_f32_32x32x16_bf16 v[80:95], v[156:159], v[164:167], v[80:95]
    ds_read_b128 v[104:107], v44 offset:4096
    ds_read_b128 v[108:111], v41 offset:0
    s_add_u32 m0, s66, 66560
    s_nop 0
    buffer_load_dwordx4 v3, s[52:55], s65 offen lds
    s_waitcnt lgkmcnt(7)
    v_mfma_f32_32x32x16_bf16 v[64:79], v[168:171], v[172:175], v[64:79]
    ds_read_b128 v[112:115], v45 offset:0
    ds_read_b128 v[116:119], v45 offset:4096
    s_add_u32 m0, s66, 67584
    s_nop 0
    buffer_load_dwordx4 v4, s[52:55], s65 offen lds
    v_mfma_f32_32x32x16_bf16 v[80:95], v[168:171], v[176:179], v[80:95]
    ds_read_b128 v[120:123], v42 offset:0
    ds_read_b128 v[124:127], v46 offset:0
    s_add_u32 m0, s66, 68608
    s_nop 0
    buffer_load_dwordx4 v5, s[52:55], s65 offen lds
    s_waitcnt lgkmcnt(8)
    v_mfma_f32_32x32x16_bf16 v[64:79], v[180:183], v[184:187], v[64:79]
    ds_read_b128 v[128:131], v46 offset:4096
    ds_read_b128 v[132:135], v43 offset:0
    v_mfma_f32_32x32x16_bf16 v[80:95], v[180:183], v[188:191], v[80:95]
    ds_read_b128 v[136:139], v47 offset:0
    ds_read_b128 v[140:143], v47 offset:4096
    s_waitcnt lgkmcnt(9)
    v_mfma_f32_32x32x16_bf16 v[64:79], v[96:99], v[100:103], v[64:79]
    v_mfma_f32_32x32x16_bf16 v[80:95], v[96:99], v[104:107], v[80:95]
    s_waitcnt vmcnt(4)
    s_barrier
    s_waitcnt lgkmcnt(6)
    v_mfma_f32_32x32x16_bf16 v[64:79], v[108:111], v[112:115], v[64:79]
    ds_read_b128 v[144:147], v40 offset:32768
    ds_read_b128 v[148:151], v44 offset:32768
    s_add_u32 s65, s76, 896
    s_and_b32 s65, s65, 0x380
    s_add_u32 s65, s65, s64
    s_add_u32 m0, s66, 98304
    s_nop 0
    buffer_load_dwordx4 v2, s[52:55], s65 offen lds
    v_mfma_f32_32x32x16_bf16 v[80:95], v[108:111], v[116:119], v[80:95]
    ds_read_b128 v[152:155], v44 offset:36864
    ds_read_b128 v[156:159], v41 offset:32768
    s_add_u32 m0, s66, 99328
    s_nop 0
    buffer_load_dwordx4 v3, s[52:55], s65 offen lds
    s_waitcnt lgkmcnt(7)
    v_mfma_f32_32x32x16_bf16 v[64:79], v[120:123], v[124:127], v[64:79]
    ds_read_b128 v[160:163], v45 offset:32768
    ds_read_b128 v[164:167], v45 offset:36864
    s_add_u32 m0, s66, 100352
    s_nop 0
    buffer_load_dwordx4 v4, s[52:55], s65 offen lds
    v_mfma_f32_32x32x16_bf16 v[80:95], v[120:123], v[128:131], v[80:95]
    ds_read_b128 v[168:171], v42 offset:32768
    ds_read_b128 v[172:175], v46 offset:32768
    s_add_u32 m0, s66, 101376
    s_nop 0
    buffer_load_dwordx4 v5, s[52:55], s65 offen lds
    s_waitcnt lgkmcnt(8)
    v_mfma_f32_32x32x16_bf16 v[64:79], v[132:135], v[136:139], v[64:79]
    ds_read_b128 v[176:179], v46 offset:36864
    ds_read_b128 v[180:183], v43 offset:32768
    v_mfma_f32_32x32x16_bf16 v[80:95], v[132:135], v[140:143], v[80:95]
    ds_read_b128 v[184:187], v47 offset:32768
    ds_read_b128 v[188:191], v47 offset:36864
    s_waitcnt lgkmcnt(9)
    v_mfma_f32_32x32x16_bf16 v[64:79], v[144:147], v[148:151], v[64:79]
    v_mfma_f32_32x32x16_bf16 v[80:95], v[144:147], v[152:155], v[80:95]
    v_xor_b32 v40, 0x10000, v40
    v_xor_b32 v41, 0x10000, v41
    v_xor_b32 v42, 0x10000, v42
    v_xor_b32 v43, 0x10000, v43
    v_xor_b32 v44, 0x10000, v44
    v_xor_b32 v45, 0x10000, v45
    v_xor_b32 v46, 0x10000, v46
    v_xor_b32 v47, 0x10000, v47
    s_waitcnt vmcnt(4)
    s_barrier
    s_waitcnt lgkmcnt(6)
    v_mfma_f32_32x32x16_bf16 v[64:79], v[156:159], v[160:163], v[64:79]
    ds_read_b128 v[96:99], v40 offset:0
    ds_read_b128 v[100:103], v44 offset:0
    v_mfma_f32_32x32x16_bf16 v[80:95], v[156:159], v[164:167], v[80:95]
    ds_read_b128 v[104:107], v44 offset:4096
    ds_read_b128 v[108:111], v41 offset:0
    s_waitcnt lgkmcnt(7)
    v_mfma_f32_32x32x16_bf16 v[64:79], v[168:171], v[172:175], v[64:79]
    ds_read_b128 v[112:115], v45 offset:0
    ds_read_b128 v[116:119], v45 offset:4096
    v_mfma_f32_32x32x16_bf16 v[80:95], v[168:171], v[176:179], v[80:95]
    ds_read_b128 v[120:123], v42 offset:0
    ds_read_b128 v[124:127], v46 offset:0
    s_waitcnt lgkmcnt(8)
    v_mfma_f32_32x32x16_bf16 v[64:79], v[180:183], v[184:187], v[64:79]
    ds_read_b128 v[128:131], v46 offset:4096
    ds_read_b128 v[132:135], v43 offset:0
    v_mfma_f32_32x32x16_bf16 v[80:95], v[180:183], v[188:191], v[80:95]
    ds_read_b128 v[136:139], v47 offset:0
    ds_read_b128 v[140:143], v47 offset:4096
    s_waitcnt lgkmcnt(9)
    v_mfma_f32_32x32x16_bf16 v[64:79], v[96:99], v[100:103], v[64:79]
    v_mfma_f32_32x32x16_bf16 v[80:95], v[96:99], v[104:107], v[80:95]
    s_waitcnt vmcnt(0)
    s_barrier
    s_waitcnt lgkmcnt(6)
    v_mfma_f32_32x32x16_bf16 v[64:79], v[108:111], v[112:115], v[64:79]
    ds_read_b128 v[144:147], v40 offset:32768
    ds_read_b128 v[148:151], v44 offset:32768
    v_mfma_f32_32x32x16_bf16 v[80:95], v[108:111], v[116:119], v[80:95]
    ds_read_b128 v[152:155], v44 offset:36864
    ds_read_b128 v[156:159], v41 offset:32768
    s_waitcnt lgkmcnt(7)
    v_mfma_f32_32x32x16_bf16 v[64:79], v[120:123], v[124:127], v[64:79]
    ds_read_b128 v[160:163], v45 offset:32768
    ds_read_b128 v[164:167], v45 offset:36864
    v_mfma_f32_32x32x16_bf16 v[80:95], v[120:123], v[128:131], v[80:95]
    ds_read_b128 v[168:171], v42 offset:32768
    ds_read_b128 v[172:175], v46 offset:32768
    s_waitcnt lgkmcnt(8)
    v_mfma_f32_32x32x16_bf16 v[64:79], v[132:135], v[136:139], v[64:79]
    ds_read_b128 v[176:179], v46 offset:36864
    ds_read_b128 v[180:183], v43 offset:32768
    v_mfma_f32_32x32x16_bf16 v[80:95], v[132:135], v[140:143], v[80:95]
    ds_read_b128 v[184:187], v47 offset:32768
    ds_read_b128 v[188:191], v47 offset:36864
    s_waitcnt lgkmcnt(9)
    v_mfma_f32_32x32x16_bf16 v[64:79], v[144:147], v[148:151], v[64:79]
    v_mfma_f32_32x32x16_bf16 v[80:95], v[144:147], v[152:155], v[80:95]
    s_waitcnt lgkmcnt(6)
    v_mfma_f32_32x32x16_bf16 v[64:79], v[156:159], v[160:163], v[64:79]
    v_mfma_f32_32x32x16_bf16 v[80:95], v[156:159], v[164:167], v[80:95]
    s_waitcnt lgkmcnt(3)
    v_mfma_f32_32x32x16_bf16 v[64:79], v[168:171], v[172:175], v[64:79]
    v_mfma_f32_32x32x16_bf16 v[80:95], v[168:171], v[176:179], v[80:95]
    s_waitcnt lgkmcnt(0)
    v_mfma_f32_32x32x16_bf16 v[64:79], v[180:183], v[184:187], v[64:79]
    v_mfma_f32_32x32x16_bf16 v[80:95], v[180:183], v[188:191], v[80:95]
    v_and_b32 v16, 31, v1
    v_lshlrev_b32 v16, 3, v16
    v_lshl_add_u32 v16, v6, 9, v16
    s_lshl_b32 s63, s6, 10
    s_lshl_b32 s69, s7, 8
    s_add_u32 s63, s63, s69
    s_add_u32 s63, s63, 0x20000
    v_add_u32 v18, s63, v16
s_nop 15
s_nop 7
s_barrier
    v_pk_mul_f32 v[112:113], v[64:65], v[56:57] op_sel:[0,0] op_sel_hi:[0,1]
    v_pk_mul_f32 v[114:115], v[64:65], v[56:57] op_sel:[1,0] op_sel_hi:[1,1]
    v_pk_fma_f32 v[112:113], v[80:81], v[56:57], v[112:113] op_sel:[0,1,0] op_sel_hi:[0,0,1] neg_hi:[0,1,0]
    v_pk_fma_f32 v[114:115], v[80:81], v[56:57], v[114:115] op_sel:[1,1,0] op_sel_hi:[1,0,1] neg_hi:[0,1,0]
    v_pk_mul_f32 v[116:117], v[66:67], v[56:57] op_sel:[0,0] op_sel_hi:[0,1]
    v_pk_fma_f32 v[20:21], v[52:53], v[112:113], v[114:115] op_sel:[0,0,0] op_sel_hi:[0,1,1]
    v_pk_fma_f32 v[116:117], v[82:83], v[56:57], v[116:117] op_sel:[0,1,0] op_sel_hi:[0,0,1] neg_hi:[0,1,0]
    v_pk_fma_f32 v[20:21], v[52:53], v[112:113], v[20:21] op_sel:[1,1,0] op_sel_hi:[1,0,1] neg_lo:[1,0,0]
    v_pk_mul_f32 v[118:119], v[66:67], v[56:57] op_sel:[1,0] op_sel_hi:[1,1]
    v_pk_fma_f32 v[22:23], v[52:53], v[20:21], v[116:117] op_sel:[0,0,0] op_sel_hi:[0,1,1]
    v_pk_fma_f32 v[118:119], v[82:83], v[56:57], v[118:119] op_sel:[1,1,0] op_sel_hi:[1,0,1] neg_hi:[0,1,0]
    v_pk_fma_f32 v[22:23], v[52:53], v[20:21], v[22:23] op_sel:[1,1,0] op_sel_hi:[1,0,1] neg_lo:[1,0,0]
    v_pk_mul_f32 v[120:121], v[68:69], v[56:57] op_sel:[0,0] op_sel_hi:[0,1]
    v_pk_fma_f32 v[20:21], v[52:53], v[22:23], v[118:119] op_sel:[0,0,0] op_sel_hi:[0,1,1]
    v_pk_fma_f32 v[120:121], v[84:85], v[56:57], v[120:121] op_sel:[0,1,0] op_sel_hi:[0,0,1] neg_hi:[0,1,0]
    v_pk_fma_f32 v[20:21], v[52:53], v[22:23], v[20:21] op_sel:[1,1,0] op_sel_hi:[1,0,1] neg_lo:[1,0,0]
    v_pk_mul_f32 v[122:123], v[68:69], v[56:57] op_sel:[1,0] op_sel_hi:[1,1]
    v_pk_fma_f32 v[22:23], v[52:53], v[20:21], v[120:121] op_sel:[0,0,0] op_sel_hi:[0,1,1]
    v_pk_fma_f32 v[122:123], v[84:85], v[56:57], v[122:123] op_sel:[1,1,0] op_sel_hi:[1,0,1] neg_hi:[0,1,0]
    v_pk_fma_f32 v[22:23], v[52:53], v[20:21], v[22:23] op_sel:[1,1,0] op_sel_hi:[1,0,1] neg_lo:[1,0,0]
    v_pk_mul_f32 v[124:125], v[70:71], v[56:57] op_sel:[0,0] op_sel_hi:[0,1]
    v_pk_fma_f32 v[20:21], v[52:53], v[22:23], v[122:123] op_sel:[0,0,0] op_sel_hi:[0,1,1]
    v_pk_fma_f32 v[124:125], v[86:87], v[56:57], v[124:125] op_sel:[0,1,0] op_sel_hi:[0,0,1] neg_hi:[0,1,0]
    v_pk_fma_f32 v[20:21], v[52:53], v[22:23], v[20:21] op_sel:[1,1,0] op_sel_hi:[1,0,1] neg_lo:[1,0,0]
    v_pk_mul_f32 v[126:127], v[70:71], v[56:57] op_sel:[1,0] op_sel_hi:[1,1]
    v_pk_fma_f32 v[22:23], v[52:53], v[20:21], v[124:125] op_sel:[0,0,0] op_sel_hi:[0,1,1]
    v_pk_fma_f32 v[126:127], v[86:87], v[56:57], v[126:127] op_sel:[1,1,0] op_sel_hi:[1,0,1] neg_hi:[0,1,0]
    v_pk_fma_f32 v[22:23], v[52:53], v[20:21], v[22:23] op_sel:[1,1,0] op_sel_hi:[1,0,1] neg_lo:[1,0,0]
    v_pk_mul_f32 v[128:129], v[72:73], v[56:57] op_sel:[0,0] op_sel_hi:[0,1]
    v_pk_fma_f32 v[20:21], v[52:53], v[22:23], v[126:127] op_sel:[0,0,0] op_sel_hi:[0,1,1]
    v_pk_fma_f32 v[128:129], v[88:89], v[56:57], v[128:129] op_sel:[0,1,0] op_sel_hi:[0,0,1] neg_hi:[0,1,0]
    v_pk_fma_f32 v[20:21], v[52:53], v[22:23], v[20:21] op_sel:[1,1,0] op_sel_hi:[1,0,1] neg_lo:[1,0,0]
    v_pk_mul_f32 v[130:131], v[72:73], v[56:57] op_sel:[1,0] op_sel_hi:[1,1]
    v_pk_fma_f32 v[22:23], v[52:53], v[20:21], v[128:129] op_sel:[0,0,0] op_sel_hi:[0,1,1]
    v_pk_fma_f32 v[130:131], v[88:89], v[56:57], v[130:131] op_sel:[1,1,0] op_sel_hi:[1,0,1] neg_hi:[0,1,0]
    v_pk_fma_f32 v[22:23], v[52:53], v[20:21], v[22:23] op_sel:[1,1,0] op_sel_hi:[1,0,1] neg_lo:[1,0,0]
    v_pk_mul_f32 v[132:133], v[74:75], v[56:57] op_sel:[0,0] op_sel_hi:[0,1]
    v_pk_fma_f32 v[20:21], v[52:53], v[22:23], v[130:131] op_sel:[0,0,0] op_sel_hi:[0,1,1]
    v_pk_fma_f32 v[132:133], v[90:91], v[56:57], v[132:133] op_sel:[0,1,0] op_sel_hi:[0,0,1] neg_hi:[0,1,0]
    v_pk_fma_f32 v[20:21], v[52:53], v[22:23], v[20:21] op_sel:[1,1,0] op_sel_hi:[1,0,1] neg_lo:[1,0,0]
    v_pk_mul_f32 v[134:135], v[74:75], v[56:57] op_sel:[1,0] op_sel_hi:[1,1]
    v_pk_fma_f32 v[22:23], v[52:53], v[20:21], v[132:133] op_sel:[0,0,0] op_sel_hi:[0,1,1]
    v_pk_fma_f32 v[134:135], v[90:91], v[56:57], v[134:135] op_sel:[1,1,0] op_sel_hi:[1,0,1] neg_hi:[0,1,0]
    v_pk_fma_f32 v[22:23], v[52:53], v[20:21], v[22:23] op_sel:[1,1,0] op_sel_hi:[1,0,1] neg_lo:[1,0,0]
    v_pk_mul_f32 v[136:137], v[76:77], v[56:57] op_sel:[0,0] op_sel_hi:[0,1]
    v_pk_fma_f32 v[20:21], v[52:53], v[22:23], v[134:135] op_sel:[0,0,0] op_sel_hi:[0,1,1]
    v_pk_fma_f32 v[136:137], v[92:93], v[56:57], v[136:137] op_sel:[0,1,0] op_sel_hi:[0,0,1] neg_hi:[0,1,0]
    v_pk_fma_f32 v[20:21], v[52:53], v[22:23], v[20:21] op_sel:[1,1,0] op_sel_hi:[1,0,1] neg_lo:[1,0,0]
    v_pk_mul_f32 v[138:139], v[76:77], v[56:57] op_sel:[1,0] op_sel_hi:[1,1]
    v_pk_fma_f32 v[22:23], v[52:53], v[20:21], v[136:137] op_sel:[0,0,0] op_sel_hi:[0,1,1]
    v_pk_fma_f32 v[138:139], v[92:93], v[56:57], v[138:139] op_sel:[1,1,0] op_sel_hi:[1,0,1] neg_hi:[0,1,0]
    v_pk_fma_f32 v[22:23], v[52:53], v[20:21], v[22:23] op_sel:[1,1,0] op_sel_hi:[1,0,1] neg_lo:[1,0,0]
    v_pk_mul_f32 v[140:141], v[78:79], v[56:57] op_sel:[0,0] op_sel_hi:[0,1]
    v_pk_fma_f32 v[20:21], v[52:53], v[22:23], v[138:139] op_sel:[0,0,0] op_sel_hi:[0,1,1]
    v_pk_fma_f32 v[140:141], v[94:95], v[56:57], v[140:141] op_sel:[0,1,0] op_sel_hi:[0,0,1] neg_hi:[0,1,0]
    v_pk_fma_f32 v[20:21], v[52:53], v[22:23], v[20:21] op_sel:[1,1,0] op_sel_hi:[1,0,1] neg_lo:[1,0,0]
    v_pk_mul_f32 v[142:143], v[78:79], v[56:57] op_sel:[1,0] op_sel_hi:[1,1]
    v_pk_fma_f32 v[22:23], v[52:53], v[20:21], v[140:141] op_sel:[0,0,0] op_sel_hi:[0,1,1]
    v_pk_fma_f32 v[142:143], v[94:95], v[56:57], v[142:143] op_sel:[1,1,0] op_sel_hi:[1,0,1] neg_hi:[0,1,0]
    v_pk_fma_f32 v[22:23], v[52:53], v[20:21], v[22:23] op_sel:[1,1,0] op_sel_hi:[1,0,1] neg_lo:[1,0,0]
    v_pk_fma_f32 v[20:21], v[52:53], v[22:23], v[142:143] op_sel:[0,0,0] op_sel_hi:[0,1,1]
    v_pk_fma_f32 v[20:21], v[52:53], v[22:23], v[20:21] op_sel:[1,1,0] op_sel_hi:[1,0,1] neg_lo:[1,0,0]
    ds_write_b64 v18, v[20:21] offset:3584
    s_waitcnt lgkmcnt(0)
    s_barrier
    ds_read_b64 v[24:25], v18 offset:0
    ds_read_b64 v[26:27], v18 offset:512
    ds_read_b64 v[28:29], v18 offset:1024
    ds_read_b64 v[30:31], v18 offset:1536
    ds_read_b64 v[32:33], v18 offset:2048
    ds_read_b64 v[34:35], v18 offset:2560
    ds_read_b64 v[36:37], v18 offset:3072
    s_lshl_b32 s63, s4, 6
    v_add_u32 v19, s63, v19
    v_lshlrev_b32 v17, 4, v19
    v_lshl_add_u32 v17, v6, 14, v17
    s_lshl_b32 s63, s3, 18
    s_lshr_b32 s69, s6, 1
    s_lshl_b32 s69, s69, 17
    s_add_u32 s63, s63, s69
    s_and_b32 s69, s6, 1
    s_lshl_b32 s69, s69, 15
    s_add_u32 s72, s63, s69
    s_add_u32 s73, s72, 0x2000
    s_add_u32 s74, s72, 0x10000
    s_add_u32 s75, s72, 0x12000
    s_waitcnt lgkmcnt(5)
    v_pk_fma_f32 v[26:27], v[54:55], v[24:25], v[26:27] op_sel:[0,0,0] op_sel_hi:[0,1,1]
    v_pk_fma_f32 v[26:27], v[54:55], v[24:25], v[26:27] op_sel:[1,1,0] op_sel_hi:[1,0,1] neg_lo:[1,0,0]
    s_waitcnt lgkmcnt(4)
    v_pk_fma_f32 v[28:29], v[54:55], v[26:27], v[28:29] op_sel:[0,0,0] op_sel_hi:[0,1,1]
    v_pk_fma_f32 v[28:29], v[54:55], v[26:27], v[28:29] op_sel:[1,1,0] op_sel_hi:[1,0,1] neg_lo:[1,0,0]
    s_waitcnt lgkmcnt(3)
    v_pk_fma_f32 v[30:31], v[54:55], v[28:29], v[30:31] op_sel:[0,0,0] op_sel_hi:[0,1,1]
    v_pk_fma_f32 v[30:31], v[54:55], v[28:29], v[30:31] op_sel:[1,1,0] op_sel_hi:[1,0,1] neg_lo:[1,0,0]
    s_waitcnt lgkmcnt(2)
    v_pk_fma_f32 v[32:33], v[54:55], v[30:31], v[32:33] op_sel:[0,0,0] op_sel_hi:[0,1,1]
    v_pk_fma_f32 v[32:33], v[54:55], v[30:31], v[32:33] op_sel:[1,1,0] op_sel_hi:[1,0,1] neg_lo:[1,0,0]
    s_waitcnt lgkmcnt(1)
    v_pk_fma_f32 v[34:35], v[54:55], v[32:33], v[34:35] op_sel:[0,0,0] op_sel_hi:[0,1,1]
    v_pk_fma_f32 v[34:35], v[54:55], v[32:33], v[34:35] op_sel:[1,1,0] op_sel_hi:[1,0,1] neg_lo:[1,0,0]
    s_waitcnt lgkmcnt(0)
    v_pk_fma_f32 v[36:37], v[54:55], v[34:35], v[36:37] op_sel:[0,0,0] op_sel_hi:[0,1,1]
    v_pk_fma_f32 v[36:37], v[54:55], v[34:35], v[36:37] op_sel:[1,1,0] op_sel_hi:[1,0,1] neg_lo:[1,0,0]
    v_pk_fma_f32 v[112:113], v[52:53], v[36:37], v[112:113] op_sel:[0,0,0] op_sel_hi:[0,1,1]
    v_pk_fma_f32 v[112:113], v[52:53], v[36:37], v[112:113] op_sel:[1,1,0] op_sel_hi:[1,0,1] neg_lo:[1,0,0]
    v_pk_fma_f32 v[114:115], v[52:53], v[112:113], v[114:115] op_sel:[0,0,0] op_sel_hi:[0,1,1]
    v_pk_fma_f32 v[114:115], v[52:53], v[112:113], v[114:115] op_sel:[1,1,0] op_sel_hi:[1,0,1] neg_lo:[1,0,0]
    v_pk_fma_f32 v[116:117], v[52:53], v[114:115], v[116:117] op_sel:[0,0,0] op_sel_hi:[0,1,1]
    v_cvt_pk_bf16_f32 v96, v112, v114
    v_pk_fma_f32 v[116:117], v[52:53], v[114:115], v[116:117] op_sel:[1,1,0] op_sel_hi:[1,0,1] neg_lo:[1,0,0]
    v_cvt_pk_bf16_f32 v104, v113, v115
    v_pk_fma_f32 v[118:119], v[52:53], v[116:117], v[118:119] op_sel:[0,0,0] op_sel_hi:[0,1,1]
    v_pk_fma_f32 v[118:119], v[52:53], v[116:117], v[118:119] op_sel:[1,1,0] op_sel_hi:[1,0,1] neg_lo:[1,0,0]
    v_pk_fma_f32 v[120:121], v[52:53], v[118:119], v[120:121] op_sel:[0,0,0] op_sel_hi:[0,1,1]
    v_cvt_pk_bf16_f32 v97, v116, v118
    v_pk_fma_f32 v[120:121], v[52:53], v[118:119], v[120:121] op_sel:[1,1,0] op_sel_hi:[1,0,1] neg_lo:[1,0,0]
    v_cvt_pk_bf16_f32 v105, v117, v119
    v_pk_fma_f32 v[122:123], v[52:53], v[120:121], v[122:123] op_sel:[0,0,0] op_sel_hi:[0,1,1]
    v_pk_fma_f32 v[122:123], v[52:53], v[120:121], v[122:123] op_sel:[1,1,0] op_sel_hi:[1,0,1] neg_lo:[1,0,0]
    v_pk_fma_f32 v[124:125], v[52:53], v[122:123], v[124:125] op_sel:[0,0,0] op_sel_hi:[0,1,1]
    v_cvt_pk_bf16_f32 v98, v120, v122
    v_pk_fma_f32 v[124:125], v[52:53], v[122:123], v[124:125] op_sel:[1,1,0] op_sel_hi:[1,0,1] neg_lo:[1,0,0]
    v_cvt_pk_bf16_f32 v106, v121, v123
    v_pk_fma_f32 v[126:127], v[52:53], v[124:125], v[126:127] op_sel:[0,0,0] op_sel_hi:[0,1,1]
    v_pk_fma_f32 v[126:127], v[52:53], v[124:125], v[126:127] op_sel:[1,1,0] op_sel_hi:[1,0,1] neg_lo:[1,0,0]
    v_pk_fma_f32 v[128:129], v[52:53], v[126:127], v[128:129] op_sel:[0,0,0] op_sel_hi:[0,1,1]
    v_cvt_pk_bf16_f32 v99, v124, v126
    v_pk_fma_f32 v[128:129], v[52:53], v[126:127], v[128:129] op_sel:[1,1,0] op_sel_hi:[1,0,1] neg_lo:[1,0,0]
    v_cvt_pk_bf16_f32 v107, v125, v127
    buffer_store_dwordx4 v[96:99], v17, s[56:59], s72 offen sc0 sc1
    buffer_store_dwordx4 v[104:107], v17, s[56:59], s74 offen sc0 sc1
    v_pk_fma_f32 v[130:131], v[52:53], v[128:129], v[130:131] op_sel:[0,0,0] op_sel_hi:[0,1,1]
    v_pk_fma_f32 v[130:131], v[52:53], v[128:129], v[130:131] op_sel:[1,1,0] op_sel_hi:[1,0,1] neg_lo:[1,0,0]
    v_pk_fma_f32 v[132:133], v[52:53], v[130:131], v[132:133] op_sel:[0,0,0] op_sel_hi:[0,1,1]
    v_cvt_pk_bf16_f32 v100, v128, v130
    v_pk_fma_f32 v[132:133], v[52:53], v[130:131], v[132:133] op_sel:[1,1,0] op_sel_hi:[1,0,1] neg_lo:[1,0,0]
    v_cvt_pk_bf16_f32 v108, v129, v131
    v_pk_fma_f32 v[134:135], v[52:53], v[132:133], v[134:135] op_sel:[0,0,0] op_sel_hi:[0,1,1]
    v_pk_fma_f32 v[134:135], v[52:53], v[132:133], v[134:135] op_sel:[1,1,0] op_sel_hi:[1,0,1] neg_lo:[1,0,0]
    v_pk_fma_f32 v[136:137], v[52:53], v[134:135], v[136:137] op_sel:[0,0,0] op_sel_hi:[0,1,1]
    v_cvt_pk_bf16_f32 v101, v132, v134
    v_pk_fma_f32 v[136:137], v[52:53], v[134:135], v[136:137] op_sel:[1,1,0] op_sel_hi:[1,0,1] neg_lo:[1,0,0]
    v_cvt_pk_bf16_f32 v109, v133, v135
    v_pk_fma_f32 v[138:139], v[52:53], v[136:137], v[138:139] op_sel:[0,0,0] op_sel_hi:[0,1,1]
    v_pk_fma_f32 v[138:139], v[52:53], v[136:137], v[138:139] op_sel:[1,1,0] op_sel_hi:[1,0,1] neg_lo:[1,0,0]
    v_pk_fma_f32 v[140:141], v[52:53], v[138:139], v[140:141] op_sel:[0,0,0] op_sel_hi:[0,1,1]
    v_cvt_pk_bf16_f32 v102, v136, v138
    v_pk_fma_f32 v[140:141], v[52:53], v[138:139], v[140:141] op_sel:[1,1,0] op_sel_hi:[1,0,1] neg_lo:[1,0,0]
    v_cvt_pk_bf16_f32 v110, v137, v139
    v_pk_fma_f32 v[142:143], v[52:53], v[140:141], v[142:143] op_sel:[0,0,0] op_sel_hi:[0,1,1]
    v_pk_fma_f32 v[142:143], v[52:53], v[140:141], v[142:143] op_sel:[1,1,0] op_sel_hi:[1,0,1] neg_lo:[1,0,0]
    v_cvt_pk_bf16_f32 v103, v140, v142
    v_cvt_pk_bf16_f32 v111, v141, v143
    buffer_store_dwordx4 v[100:103], v17, s[56:59], s73 offen sc0 sc1
    buffer_store_dwordx4 v[108:111], v17, s[56:59], s75 offen sc0 sc1
    s_cmp_lg_u32 s6, 3
    s_cbranch_scc1 L_noE_1
    v_cvt_pk_bf16_f32 v20, v142, v143
    v_lshlrev_b32 v17, 4, v19
    s_lshr_b32 s63, s3, 2
    s_lshl_b32 s63, s63, 13
    s_and_b32 s69, s3, 3
    s_lshl_b32 s69, s69, 2
    s_add_u32 s63, s63, s69
    s_add_u32 s63, s63, 0x400000
    s_mov_b32 exec_lo, 0
    buffer_store_dword v20, v17, s[56:59], s63 offen sc0 sc1
L_noE_1:
    s_endpgm
L_conv:
    v_and_b32 v1, 63, v0
    v_lshrrev_b32 v2, 6, v0
    s_lshl_b32 s3, s3, 6
    s_and_b32 s4, s4, 15
    s_lshl_b32 s5, s4, 5
    v_add_u32 v248, s5, v0
    v_and_b32 v248, 0x1ff, v248
    v_readfirstlane_b32 s5, v2
    s_lshl_b32 s4, s4, 2
    s_add_u32 s3, s3, s4
    s_lshl_b32 s60, s3, 1
    v_lshlrev_b32 v2, 12, v248
    v_add_u32 v2, s60, v2
    s_and_b32 s6, s5, 3
    s_lshr_b32 s7, s5, 2
    s_add_u32 s4, s3, s6
    s_lshl_b32 s60, s4, 8
    s_lshl_b32 s61, s7, 7
    s_add_u32 s60, s60, s61
    v_lshl_add_u32 v3, v1, 1, s60
    s_lshl_b32 s61, s4, 1
    v_mov_b32 v4, s61
    s_waitcnt lgkmcnt(0)
    global_load_ushort v8, v3, s[28:29]
    global_load_ushort v9, v3, s[30:31]
    global_load_ushort v10, v3, s[32:33]
    global_load_ushort v11, v3, s[34:35]
    global_load_ushort v12, v3, s[36:37]
    global_load_ushort v13, v3, s[38:39]
    global_load_ushort v14, v4, s[40:41]
    global_load_ushort v15, v4, s[42:43]
    s_barrier
    global_load_dwordx2 v[240:241], v2, s[8:9] offset:0
    s_mov_b32 s56, s50
    s_mov_b32 s57, s51
    s_mov_b32 s58, 0x1000000
    s_mov_b32 s59, 0x00020000
    s_mul_i32 s62, s6, 4992
    s_add_u32 s62, s62, 136192
    s_mul_i32 s63, s7, 2496
    s_add_u32 s63, s63, s62
    s_mul_i32 s64, s6, 4608
    s_add_u32 s64, s64, 117760
    v_mov_b32 v16, 0
    v_mov_b32 v17, 0
    v_mov_b32 v18, 0
    v_mov_b32 v19, 0
    v_lshl_add_u32 v5, v1, 4, s63
    ds_write_b128 v5, v[16:19]
    ds_write_b128 v5, v[16:19] offset:1024
    s_nop 1
    v_lshl_add_u32 v5, v1, 3, s63
    ds_write_b64 v5, v[16:17] offset:2048
    v_lshl_add_u32 v5, v1, 3, s64
    ds_write_b64 v5, v[16:17]
    v_and_b32 v6, 15, v1
    v_lshrrev_b32 v7, 4, v1
    v_mul_u32_u24 v5, 49, v7
    v_add3_u32 v5, v5, v6, s7
    v_lshl_add_u32 v5, v5, 1, s63
    v_lshl_add_u32 v16, v7, 1, 2
    v_mov_b32 v17, 0x3f80
    v_cmp_le_u32 vcc, v6, v16
    s_and_saveexec_b64 s[70:71], vcc
    ds_write_b16 v5, v17 offset:2100
    s_mov_b64 exec, s[70:71]
    s_lshl_b32 s65, s6, 9
    s_lshl_b32 s66, s7, 8
    s_add_u32 s65, s65, s66
    s_add_u32 s66, s65, 63984
    s_mov_b32 m0, s65
    s_waitcnt vmcnt(1)
    v_lshlrev_b32 v8, 16, v8
    v_lshlrev_b32 v9, 16, v9
    v_lshlrev_b32 v10, 16, v10
    v_lshlrev_b32 v11, 16, v11
    v_lshlrev_b32 v12, 16, v12
    v_lshlrev_b32 v13, 16, v13
    v_lshlrev_b32 v14, 16, v14
    v_lshlrev_b32 v15, 16, v15
    v_mul_f32 v14, 0x3fb8aa3b, v14
    v_exp_f32 v14, v14
    s_nop 0
    v_cvt_pk_bf16_f32 v14, v14, v14
    v_lshlrev_b32 v14, 16, v14
    v_mul_f32 v8, v14, v8
    v_mul_f32 v9, v14, v9
    v_mul_f32 v10, v14, v10
    v_mul_f32 v11, v14, v11
    v_mul_f32 v8, 0x3fb8aa3b, v8
    v_mul_f32 v9, 0x3e22f983, v9
    v_exp_f32 v16, v8
    v_fract_f32 v17, v9
    v_cos_f32 v34, v17
    v_sin_f32 v35, v17
    v_mul_f32 v34, v34, v16
    v_mul_f32 v35, v35, v16
    v_mul_f32 v18, 0x41800000, v8
    v_mul_f32 v19, 0x41800000, v9
    v_exp_f32 v18, v18
    v_fract_f32 v19, v19
    v_cos_f32 v64, v19
    v_sin_f32 v65, v19
    v_mul_f32 v64, v64, v18
    v_mul_f32 v65, v65, v18
    v_mul_f32 v16, 0x43800000, v8
    v_mul_f32 v17, 0x43800000, v9
    v_exp_f32 v16, v16
    v_fract_f32 v17, v17
    v_cos_f32 v68, v17
    v_sin_f32 v69, v17
    v_mul_f32 v68, v68, v16
    v_mul_f32 v69, v69, v16
    global_load_dwordx2 v[242:243], v2, s[8:9] offset:1024
    v_pk_mul_f32 v[24:25], v[12:13], v[10:11] op_sel:[0,0] op_sel_hi:[0,1]
    v_pk_mul_f32 v[36:37], v[34:35], v[34:35] op_sel:[0,0] op_sel_hi:[0,1]
    v_pk_fma_f32 v[24:25], v[12:13], v[10:11], v[24:25] op_sel:[1,1,0] op_sel_hi:[1,0,1] neg_lo:[1,0,0]
    v_pk_fma_f32 v[36:37], v[34:35], v[34:35], v[36:37] op_sel:[1,1,0] op_sel_hi:[1,0,1] neg_lo:[1,0,0]
    v_mov_b32 v28, 0x3f80
    ds_write_addtid_b32 v28 offset:33024
    v_cvt_pk_bf16_f32 v20, v34, v35
    ds_write_addtid_b32 v20 offset:35088
    v_cvt_pk_bf16_f32 v21, v24, -v25
    ds_write_addtid_b32 v21 offset:0
    v_pk_mul_f32 v[26:27], v[24:25], v[64:65] op_sel:[0,0] op_sel_hi:[0,1]
    v_pk_mul_f32 v[38:39], v[34:35], v[36:37] op_sel:[0,0] op_sel_hi:[0,1]
    v_cvt_pk_bf16_f32 v23, v36, v37
    v_pk_fma_f32 v[26:27], v[24:25], v[64:65], v[26:27] op_sel:[1,1,0] op_sel_hi:[1,0,1] neg_lo:[1,0,0]
    v_pk_fma_f32 v[38:39], v[34:35], v[36:37], v[38:39] op_sel:[1,1,0] op_sel_hi:[1,0,1] neg_lo:[1,0,0]
    ds_write_addtid_b32 v23 offset:37152
    v_cvt_pk_bf16_f32 v22, v26, -v27
    ds_write_addtid_b32 v22 offset:2064
    v_pk_mul_f32 v[24:25], v[26:27], v[64:65] op_sel:[0,0] op_sel_hi:[0,1]
    v_pk_mul_f32 v[40:41], v[36:37], v[36:37] op_sel:[0,0] op_sel_hi:[0,1]
    v_cvt_pk_bf16_f32 v21, v38, v39
    v_pk_mul_f32 v[70:71], v[68:69], v[68:69] op_sel:[0,0] op_sel_hi:[0,1]
    v_pk_fma_f32 v[24:25], v[26:27], v[64:65], v[24:25] op_sel:[1,1,0] op_sel_hi:[1,0,1] neg_lo:[1,0,0]
    v_pk_fma_f32 v[40:41], v[36:37], v[36:37], v[40:41] op_sel:[1,1,0] op_sel_hi:[1,0,1] neg_lo:[1,0,0]
    ds_write_addtid_b32 v21 offset:39216
    v_pk_fma_f32 v[70:71], v[68:69], v[68:69], v[70:71] op_sel:[1,1,0] op_sel_hi:[1,0,1] neg_lo:[1,0,0]
    v_cvt_pk_bf16_f32 v20, v24, -v25
    ds_write_addtid_b32 v20 offset:4128
    v_pk_mul_f32 v[26:27], v[24:25], v[64:65] op_sel:[0,0] op_sel_hi:[0,1]
    v_pk_mul_f32 v[42:43], v[38:39], v[36:37] op_sel:[0,0] op_sel_hi:[0,1]
    v_cvt_pk_bf16_f32 v23, v40, v41
    v_pk_mul_f32 v[72:73], v[70:71], v[68:69] op_sel:[0,0] op_sel_hi:[0,1]
    v_pk_fma_f32 v[26:27], v[24:25], v[64:65], v[26:27] op_sel:[1,1,0] op_sel_hi:[1,0,1] neg_lo:[1,0,0]
    v_pk_fma_f32 v[42:43], v[38:39], v[36:37], v[42:43] op_sel:[1,1,0] op_sel_hi:[1,0,1] neg_lo:[1,0,0]
    ds_write_addtid_b32 v23 offset:41280
    v_pk_fma_f32 v[72:73], v[70:71], v[68:69], v[72:73] op_sel:[1,1,0] op_sel_hi:[1,0,1] neg_lo:[1,0,0]
    v_cvt_pk_bf16_f32 v22, v26, -v27
    ds_write_addtid_b32 v22 offset:6192
    v_pk_mul_f32 v[24:25], v[26:27], v[64:65] op_sel:[0,0] op_sel_hi:[0,1]
    v_pk_mul_f32 v[44:45], v[40:41], v[36:37] op_sel:[0,0] op_sel_hi:[0,1]
    v_cvt_pk_bf16_f32 v21, v42, v43
    v_pk_mul_f32 v[74:75], v[72:73], v[68:69] op_sel:[0,0] op_sel_hi:[0,1]
    v_pk_fma_f32 v[24:25], v[26:27], v[64:65], v[24:25] op_sel:[1,1,0] op_sel_hi:[1,0,1] neg_lo:[1,0,0]
    v_pk_fma_f32 v[44:45], v[40:41], v[36:37], v[44:45] op_sel:[1,1,0] op_sel_hi:[1,0,1] neg_lo:[1,0,0]
    ds_write_addtid_b32 v21 offset:43344
    v_pk_fma_f32 v[74:75], v[72:73], v[68:69], v[74:75] op_sel:[1,1,0] op_sel_hi:[1,0,1] neg_lo:[1,0,0]
    v_cvt_pk_bf16_f32 v20, v24, -v25
    ds_write_addtid_b32 v20 offset:8256
    global_load_dwordx2 v[244:245], v2, s[8:9] offset:2048
    v_pk_mul_f32 v[26:27], v[24:25], v[64:65] op_sel:[0,0] op_sel_hi:[0,1]
    v_pk_mul_f32 v[46:47], v[42:43], v[36:37] op_sel:[0,0] op_sel_hi:[0,1]
    v_cvt_pk_bf16_f32 v23, v44, v45
    v_pk_mul_f32 v[76:77], v[74:75], v[68:69] op_sel:[0,0] op_sel_hi:[0,1]
    v_pk_fma_f32 v[26:27], v[24:25], v[64:65], v[26:27] op_sel:[1,1,0] op_sel_hi:[1,0,1] neg_lo:[1,0,0]
    v_pk_fma_f32 v[46:47], v[42:43], v[36:37], v[46:47] op_sel:[1,1,0] op_sel_hi:[1,0,1] neg_lo:[1,0,0]
    ds_write_addtid_b32 v23 offset:45408
    v_pk_fma_f32 v[76:77], v[74:75], v[68:69], v[76:77] op_sel:[1,1,0] op_sel_hi:[1,0,1] neg_lo:[1,0,0]
    v_cvt_pk_bf16_f32 v22, v26, -v27
    ds_write_addtid_b32 v22 offset:10320
    v_pk_mul_f32 v[24:25], v[26:27], v[64:65] op_sel:[0,0] op_sel_hi:[0,1]
    v_pk_mul_f32 v[48:49], v[44:45], v[36:37] op_sel:[0,0] op_sel_hi:[0,1]
    v_cvt_pk_bf16_f32 v21, v46, v47
    v_pk_mul_f32 v[78:79], v[76:77], v[68:69] op_sel:[0,0] op_sel_hi:[0,1]
    v_pk_fma_f32 v[24:25], v[26:27], v[64:65], v[24:25] op_sel:[1,1,0] op_sel_hi:[1,0,1] neg_lo:[1,0,0]
    v_pk_fma_f32 v[48:49], v[44:45], v[36:37], v[48:49] op_sel:[1,1,0] op_sel_hi:[1,0,1] neg_lo:[1,0,0]
    ds_write_addtid_b32 v21 offset:47472
    v_pk_fma_f32 v[78:79], v[76:77], v[68:69], v[78:79] op_sel:[1,1,0] op_sel_hi:[1,0,1] neg_lo:[1,0,0]
    v_cvt_pk_bf16_f32 v20, v24, -v25
    ds_write_addtid_b32 v20 offset:12384
    v_pk_mul_f32 v[26:27], v[24:25], v[64:65] op_sel:[0,0] op_sel_hi:[0,1]
    v_pk_mul_f32 v[50:51], v[46:47], v[36:37] op_sel:[0,0] op_sel_hi:[0,1]
    v_cvt_pk_bf16_f32 v23, v48, v49
    v_pk_mul_f32 v[80:81], v[78:79], v[68:69] op_sel:[0,0] op_sel_hi:[0,1]
    v_pk_fma_f32 v[26:27], v[24:25], v[64:65], v[26:27] op_sel:[1,1,0] op_sel_hi:[1,0,1] neg_lo:[1,0,0]
    v_pk_fma_f32 v[50:51], v[46:47], v[36:37], v[50:51] op_sel:[1,1,0] op_sel_hi:[1,0,1] neg_lo:[1,0,0]
    ds_write_addtid_b32 v23 offset:49536
    v_pk_fma_f32 v[80:81], v[78:79], v[68:69], v[80:81] op_sel:[1,1,0] op_sel_hi:[1,0,1] neg_lo:[1,0,0]
    v_cvt_pk_bf16_f32 v22, v26, -v27
    ds_write_addtid_b32 v22 offset:14448
    v_pk_mul_f32 v[24:25], v[26:27], v[64:65] op_sel:[0,0] op_sel_hi:[0,1]
    v_pk_mul_f32 v[52:53], v[48:49], v[36:37] op_sel:[0,0] op_sel_hi:[0,1]
    v_cvt_pk_bf16_f32 v21, v50, v51
    v_pk_fma_f32 v[24:25], v[26:27], v[64:65], v[24:25] op_sel:[1,1,0] op_sel_hi:[1,0,1] neg_lo:[1,0,0]
    v_pk_fma_f32 v[52:53], v[48:49], v[36:37], v[52:53] op_sel:[1,1,0] op_sel_hi:[1,0,1] neg_lo:[1,0,0]
    ds_write_addtid_b32 v21 offset:51600
    v_cvt_pk_bf16_f32 v20, v24, -v25
    ds_write_addtid_b32 v20 offset:16512
    v_pk_mul_f32 v[26:27], v[24:25], v[64:65] op_sel:[0,0] op_sel_hi:[0,1]
    v_pk_mul_f32 v[54:55], v[50:51], v[36:37] op_sel:[0,0] op_sel_hi:[0,1]
    v_cvt_pk_bf16_f32 v23, v52, v53
    v_pk_fma_f32 v[26:27], v[24:25], v[64:65], v[26:27] op_sel:[1,1,0] op_sel_hi:[1,0,1] neg_lo:[1,0,0]
    v_pk_fma_f32 v[54:55], v[50:51], v[36:37], v[54:55] op_sel:[1,1,0] op_sel_hi:[1,0,1] neg_lo:[1,0,0]
    ds_write_addtid_b32 v23 offset:53664
    v_cvt_pk_bf16_f32 v22, v26, -v27
    ds_write_addtid_b32 v22 offset:18576
    global_load_dwordx2 v[246:247], v2, s[8:9] offset:3072
    v_pk_mul_f32 v[24:25], v[26:27], v[64:65] op_sel:[0,0] op_sel_hi:[0,1]
    v_pk_mul_f32 v[56:57], v[52:53], v[36:37] op_sel:[0,0] op_sel_hi:[0,1]
    v_cvt_pk_bf16_f32 v21, v54, v55
    v_pk_fma_f32 v[24:25], v[26:27], v[64:65], v[24:25] op_sel:[1,1,0] op_sel_hi:[1,0,1] neg_lo:[1,0,0]
    v_pk_fma_f32 v[56:57], v[52:53], v[36:37], v[56:57] op_sel:[1,1,0] op_sel_hi:[1,0,1] neg_lo:[1,0,0]
    ds_write_addtid_b32 v21 offset:55728
    v_cvt_pk_bf16_f32 v20, v24, -v25
    ds_write_addtid_b32 v20 offset:20640
    v_pk_mul_f32 v[26:27], v[24:25], v[64:65] op_sel:[0,0] op_sel_hi:[0,1]
    v_pk_mul_f32 v[58:59], v[54:55], v[36:37] op_sel:[0,0] op_sel_hi:[0,1]
    v_cvt_pk_bf16_f32 v23, v56, v57
    v_pk_fma_f32 v[26:27], v[24:25], v[64:65], v[26:27] op_sel:[1,1,0] op_sel_hi:[1,0,1] neg_lo:[1,0,0]
    v_pk_fma_f32 v[58:59], v[54:55], v[36:37], v[58:59] op_sel:[1,1,0] op_sel_hi:[1,0,1] neg_lo:[1,0,0]
    ds_write_addtid_b32 v23 offset:57792
    v_cvt_pk_bf16_f32 v22, v26, -v27
    ds_write_addtid_b32 v22 offset:22704
    v_pk_mul_f32 v[24:25], v[26:27], v[64:65] op_sel:[0,0] op_sel_hi:[0,1]
    v_pk_mul_f32 v[60:61], v[56:57], v[36:37] op_sel:[0,0] op_sel_hi:[0,1]
    v_cvt_pk_bf16_f32 v21, v58, v59
    v_pk_fma_f32 v[24:25], v[26:27], v[64:65], v[24:25] op_sel:[1,1,0] op_sel_hi:[1,0,1] neg_lo:[1,0,0]
    v_pk_fma_f32 v[60:61], v[56:57], v[36:37], v[60:61] op_sel:[1,1,0] op_sel_hi:[1,0,1] neg_lo:[1,0,0]
    ds_write_addtid_b32 v21 offset:59856
    v_cvt_pk_bf16_f32 v20, v24, -v25
    ds_write_addtid_b32 v20 offset:24768
    v_pk_mul_f32 v[26:27], v[24:25], v[64:65] op_sel:[0,0] op_sel_hi:[0,1]
    v_pk_mul_f32 v[62:63], v[58:59], v[36:37] op_sel:[0,0] op_sel_hi:[0,1]
    v_cvt_pk_bf16_f32 v23, v60, v61
    v_pk_fma_f32 v[26:27], v[24:25], v[64:65], v[26:27] op_sel:[1,1,0] op_sel_hi:[1,0,1] neg_lo:[1,0,0]
    v_pk_fma_f32 v[62:63], v[58:59], v[36:37], v[62:63] op_sel:[1,1,0] op_sel_hi:[1,0,1] neg_lo:[1,0,0]
    ds_write_addtid_b32 v23 offset:61920
    v_cvt_pk_bf16_f32 v22, v26, -v27
    ds_write_addtid_b32 v22 offset:26832
    v_pk_mul_f32 v[24:25], v[26:27], v[64:65] op_sel:[0,0] op_sel_hi:[0,1]
    v_cvt_pk_bf16_f32 v21, v62, v63
    v_pk_fma_f32 v[24:25], v[26:27], v[64:65], v[24:25] op_sel:[1,1,0] op_sel_hi:[1,0,1] neg_lo:[1,0,0]
    ds_write_addtid_b32 v21 offset:63984
    v_cvt_pk_bf16_f32 v20, v24, -v25
    ds_write_addtid_b32 v20 offset:28896
    v_pk_mul_f32 v[26:27], v[24:25], v[64:65] op_sel:[0,0] op_sel_hi:[0,1]
    v_pk_fma_f32 v[26:27], v[24:25], v[64:65], v[26:27] op_sel:[1,1,0] op_sel_hi:[1,0,1] neg_lo:[1,0,0]
    v_cvt_pk_bf16_f32 v22, v26, -v27
    ds_write_addtid_b32 v22 offset:30960
    s_mov_b32 m0, s66
    v_cvt_pk_bf16_f32 v23, v68, v69
    ds_write_addtid_b32 v23 offset:2064
    v_pk_mul_f32 v[82:83], v[68:69], v[36:37] op_sel:[0,0] op_sel_hi:[0,1]
    v_pk_mul_f32 v[84:85], v[68:69], v[40:41] op_sel:[0,0] op_sel_hi:[0,1]
    v_pk_mul_f32 v[86:87], v[68:69], v[44:45] op_sel:[0,0] op_sel_hi:[0,1]
    v_pk_mul_f32 v[88:89], v[68:69], v[48:49] op_sel:[0,0] op_sel_hi:[0,1]
    v_pk_fma_f32 v[82:83], v[68:69], v[36:37], v[82:83] op_sel:[1,1,0] op_sel_hi:[1,0,1] neg_lo:[1,0,0]
    v_pk_fma_f32 v[84:85], v[68:69], v[40:41], v[84:85] op_sel:[1,1,0] op_sel_hi:[1,0,1] neg_lo:[1,0,0]
    v_pk_fma_f32 v[86:87], v[68:69], v[44:45], v[86:87] op_sel:[1,1,0] op_sel_hi:[1,0,1] neg_lo:[1,0,0]
    v_pk_fma_f32 v[88:89], v[68:69], v[48:49], v[88:89] op_sel:[1,1,0] op_sel_hi:[1,0,1] neg_lo:[1,0,0]
    v_cvt_pk_bf16_f32 v20, v82, v83
    v_cvt_pk_bf16_f32 v21, v84, v85
    v_cvt_pk_bf16_f32 v22, v86, v87
    v_cvt_pk_bf16_f32 v23, v88, v89
    ds_write_addtid_b32 v20 offset:4128
    ds_write_addtid_b32 v21 offset:6192
    ds_write_addtid_b32 v22 offset:8256
    ds_write_addtid_b32 v23 offset:10320
    v_pk_mul_f32 v[82:83], v[68:69], v[52:53] op_sel:[0,0] op_sel_hi:[0,1]
    v_pk_mul_f32 v[84:85], v[68:69], v[56:57] op_sel:[0,0] op_sel_hi:[0,1]
    v_pk_mul_f32 v[86:87], v[68:69], v[60:61] op_sel:[0,0] op_sel_hi:[0,1]
    v_pk_mul_f32 v[88:89], v[68:69], v[64:65] op_sel:[0,0] op_sel_hi:[0,1]
    v_pk_fma_f32 v[82:83], v[68:69], v[52:53], v[82:83] op_sel:[1,1,0] op_sel_hi:[1,0,1] neg_lo:[1,0,0]
    v_pk_fma_f32 v[84:85], v[68:69], v[56:57], v[84:85] op_sel:[1,1,0] op_sel_hi:[1,0,1] neg_lo:[1,0,0]
    v_pk_fma_f32 v[86:87], v[68:69], v[60:61], v[86:87] op_sel:[1,1,0] op_sel_hi:[1,0,1] neg_lo:[1,0,0]
    v_pk_fma_f32 v[88:89], v[68:69], v[64:65], v[88:89] op_sel:[1,1,0] op_sel_hi:[1,0,1] neg_lo:[1,0,0]
    v_cvt_pk_bf16_f32 v20, v82, v83
    v_cvt_pk_bf16_f32 v21, v84, v85
    v_cvt_pk_bf16_f32 v22, v86, v87
    v_cvt_pk_bf16_f32 v23, v88, v89
    ds_write_addtid_b32 v20 offset:12384
    ds_write_addtid_b32 v21 offset:14448
    ds_write_addtid_b32 v22 offset:16512
    ds_write_addtid_b32 v23 offset:18576
    v_pk_mul_f32 v[82:83], v[70:71], v[40:41] op_sel:[0,0] op_sel_hi:[0,1]
    v_pk_mul_f32 v[84:85], v[70:71], v[48:49] op_sel:[0,0] op_sel_hi:[0,1]
    v_pk_mul_f32 v[86:87], v[70:71], v[56:57] op_sel:[0,0] op_sel_hi:[0,1]
    v_pk_mul_f32 v[88:89], v[70:71], v[64:65] op_sel:[0,0] op_sel_hi:[0,1]
    v_pk_fma_f32 v[82:83], v[70:71], v[40:41], v[82:83] op_sel:[1,1,0] op_sel_hi:[1,0,1] neg_lo:[1,0,0]
    v_pk_fma_f32 v[84:85], v[70:71], v[48:49], v[84:85] op_sel:[1,1,0] op_sel_hi:[1,0,1] neg_lo:[1,0,0]
    v_pk_fma_f32 v[86:87], v[70:71], v[56:57], v[86:87] op_sel:[1,1,0] op_sel_hi:[1,0,1] neg_lo:[1,0,0]
    v_pk_fma_f32 v[88:89], v[70:71], v[64:65], v[88:89] op_sel:[1,1,0] op_sel_hi:[1,0,1] neg_lo:[1,0,0]
    v_cvt_pk_bf16_f32 v20, v82, v83
    v_cvt_pk_bf16_f32 v21, v84, v85
    v_cvt_pk_bf16_f32 v22, v86, v87
    v_cvt_pk_bf16_f32 v23, v88, v89
    ds_write_addtid_b32 v20 offset:20640
    ds_write_addtid_b32 v21 offset:22704
    ds_write_addtid_b32 v22 offset:24768
    ds_write_addtid_b32 v23 offset:26832
    v_pk_mul_f32 v[82:83], v[72:73], v[40:41] op_sel:[0,0] op_sel_hi:[0,1]
    v_pk_mul_f32 v[84:85], v[72:73], v[48:49] op_sel:[0,0] op_sel_hi:[0,1]
    v_pk_mul_f32 v[86:87], v[72:73], v[56:57] op_sel:[0,0] op_sel_hi:[0,1]
    v_pk_mul_f32 v[88:89], v[72:73], v[64:65] op_sel:[0,0] op_sel_hi:[0,1]
    v_pk_fma_f32 v[82:83], v[72:73], v[40:41], v[82:83] op_sel:[1,1,0] op_sel_hi:[1,0,1] neg_lo:[1,0,0]
    v_pk_fma_f32 v[84:85], v[72:73], v[48:49], v[84:85] op_sel:[1,1,0] op_sel_hi:[1,0,1] neg_lo:[1,0,0]
    v_pk_fma_f32 v[86:87], v[72:73], v[56:57], v[86:87] op_sel:[1,1,0] op_sel_hi:[1,0,1] neg_lo:[1,0,0]
    v_pk_fma_f32 v[88:89], v[72:73], v[64:65], v[88:89] op_sel:[1,1,0] op_sel_hi:[1,0,1] neg_lo:[1,0,0]
    v_cvt_pk_bf16_f32 v20, v82, v83
    v_cvt_pk_bf16_f32 v21, v84, v85
    v_cvt_pk_bf16_f32 v22, v86, v87
    v_cvt_pk_bf16_f32 v23, v88, v89
    ds_write_addtid_b32 v20 offset:28896
    ds_write_addtid_b32 v21 offset:30960
    ds_write_addtid_b32 v22 offset:33024
    ds_write_addtid_b32 v23 offset:35088
    v_pk_mul_f32 v[82:83], v[74:75], v[48:49] op_sel:[0,0] op_sel_hi:[0,1]
    v_pk_mul_f32 v[84:85], v[74:75], v[64:65] op_sel:[0,0] op_sel_hi:[0,1]
    v_pk_mul_f32 v[86:87], v[76:77], v[48:49] op_sel:[0,0] op_sel_hi:[0,1]
    v_pk_mul_f32 v[88:89], v[76:77], v[64:65] op_sel:[0,0] op_sel_hi:[0,1]
    v_pk_fma_f32 v[82:83], v[74:75], v[48:49], v[82:83] op_sel:[1,1,0] op_sel_hi:[1,0,1] neg_lo:[1,0,0]
    v_pk_fma_f32 v[84:85], v[74:75], v[64:65], v[84:85] op_sel:[1,1,0] op_sel_hi:[1,0,1] neg_lo:[1,0,0]
    v_pk_fma_f32 v[86:87], v[76:77], v[48:49], v[86:87] op_sel:[1,1,0] op_sel_hi:[1,0,1] neg_lo:[1,0,0]
    v_pk_fma_f32 v[88:89], v[76:77], v[64:65], v[88:89] op_sel:[1,1,0] op_sel_hi:[1,0,1] neg_lo:[1,0,0]
    v_cvt_pk_bf16_f32 v20, v82, v83
    v_cvt_pk_bf16_f32 v21, v84, v85
    v_cvt_pk_bf16_f32 v22, v86, v87
    v_cvt_pk_bf16_f32 v23, v88, v89
    ds_write_addtid_b32 v20 offset:37152
    ds_write_addtid_b32 v21 offset:39216
    ds_write_addtid_b32 v22 offset:41280
    ds_write_addtid_b32 v23 offset:43344
    v_pk_mul_f32 v[82:83], v[78:79], v[48:49] op_sel:[0,0] op_sel_hi:[0,1]
    v_pk_mul_f32 v[84:85], v[78:79], v[64:65] op_sel:[0,0] op_sel_hi:[0,1]
    v_pk_mul_f32 v[86:87], v[80:81], v[48:49] op_sel:[0,0] op_sel_hi:[0,1]
    v_pk_mul_f32 v[88:89], v[80:81], v[64:65] op_sel:[0,0] op_sel_hi:[0,1]
    v_pk_fma_f32 v[82:83], v[78:79], v[48:49], v[82:83] op_sel:[1,1,0] op_sel_hi:[1,0,1] neg_lo:[1,0,0]
    v_pk_fma_f32 v[84:85], v[78:79], v[64:65], v[84:85] op_sel:[1,1,0] op_sel_hi:[1,0,1] neg_lo:[1,0,0]
    v_pk_fma_f32 v[86:87], v[80:81], v[48:49], v[86:87] op_sel:[1,1,0] op_sel_hi:[1,0,1] neg_lo:[1,0,0]
    v_pk_fma_f32 v[88:89], v[80:81], v[64:65], v[88:89] op_sel:[1,1,0] op_sel_hi:[1,0,1] neg_lo:[1,0,0]
    v_cvt_pk_bf16_f32 v20, v82, v83
    v_cvt_pk_bf16_f32 v21, v84, v85
    v_cvt_pk_bf16_f32 v22, v86, v87
    v_cvt_pk_bf16_f32 v23, v88, v89
    ds_write_addtid_b32 v20 offset:45408
    ds_write_addtid_b32 v21 offset:47472
    ds_write_addtid_b32 v22 offset:49536
    ds_write_addtid_b32 v23 offset:51600
    v_mul_u32_u24 v8, 2064, v6
    v_and_b32 v2, 1, v7
    v_lshlrev_b32 v2, 8, v2
    v_lshrrev_b32 v3, 1, v7
    v_lshl_add_u32 v2, v3, 7, v2
    s_lshl_b32 s65, s6, 9
    v_add_u32 v2, s65, v2
    v_add_u32 v8, v8, v2
    v_lshlrev_b32 v9, 5, v6
    v_lshl_add_u32 v9, v7, 4, v9
    v_add_u32 v9, s64, v9
    v_and_b32 v3, 1, v6
    v_xor_b32 v3, 1, v3
    v_mul_u32_u24 v3, 2498, v3
    v_sub_u32 v4, 15, v6
    v_lshl_add_u32 v3, v4, 1, v3
    v_add_u32 v3, s62, v3
    v_lshl_add_u32 v10, v7, 4, v3
    v_add_u32 v11, 1024, v10
    v_add_u32 v12, 2048, v10
    v_lshl_add_u32 v13, v7, 3, v3
    v_add_u32 v13, 1216, v13
    s_cmp_lg_u32 s7, 0
    s_cbranch_scc1 L_cvB_2
    v_bfe_u32 v3, v6, 1, 1
    v_add_u32 v3, v3, v6
    v_lshrrev_b32 v3, 1, v3
    v_mul_u32_u24 v3, 2064, v3
    v_add_u32 v3, 66048, v3
    v_add_u32 v16, v3, v2
    v_lshlrev_b32 v3, 5, v6
    v_lshl_add_u32 v3, v7, 3, v3
    s_add_u32 s65, s62, 560
    v_sub_u32 v14, s65, v3
    v_cmp_eq_u32 vcc, 0, v1
    s_nop 1
    v_cndmask_b32 v24, 0, v15, vcc
    v_mov_b32 v25, 0
    v_mov_b32 v26, 0
    v_mov_b32 v27, 0
    s_waitcnt lgkmcnt(0)
    s_barrier
    ds_read_b128 v[64:67], v8 offset:0
    ds_read_b128 v[68:71], v8 offset:33024
    ds_read_b128 v[72:75], v16 offset:0
    ds_read_b128 v[76:79], v8 offset:16
    ds_read_b128 v[80:83], v8 offset:33040
    ds_read_b128 v[84:87], v16 offset:16
    ds_read_b128 v[88:91], v8 offset:32
    ds_read_b128 v[92:95], v8 offset:33056
    ds_read_b128 v[96:99], v16 offset:32
    ds_read_b128 v[100:103], v8 offset:48
    ds_read_b128 v[104:107], v8 offset:33072
    ds_read_b128 v[108:111], v16 offset:48
    ds_read_b128 v[112:115], v8 offset:64
    ds_read_b128 v[116:119], v8 offset:33088
    s_waitcnt lgkmcnt(12)
    v_mfma_f32_16x16x32_bf16 v[24:27], v[68:71], v[64:67], v[24:27]
    ds_read_b128 v[120:123], v16 offset:64
    ds_read_b128 v[124:127], v8 offset:80
    s_waitcnt lgkmcnt(13)
    v_mfma_f32_16x16x32_bf16 v[28:31], v[72:75], v[64:67], 0
    ds_read_b128 v[128:131], v8 offset:33104
    s_waitcnt lgkmcnt(12)
    v_mfma_f32_16x16x32_bf16 v[24:27], v[80:83], v[76:79], v[24:27]
    ds_read_b128 v[132:135], v16 offset:80
    ds_read_b128 v[136:139], v8 offset:96
    s_waitcnt lgkmcnt(13)
    v_mfma_f32_16x16x32_bf16 v[28:31], v[84:87], v[76:79], v[28:31]
    ds_read_b128 v[140:143], v8 offset:33120
    s_waitcnt lgkmcnt(12)
    v_mfma_f32_16x16x32_bf16 v[24:27], v[92:95], v[88:91], v[24:27]
    ds_read_b128 v[144:147], v16 offset:96
    ds_read_b128 v[148:151], v8 offset:112
    s_waitcnt lgkmcnt(13)
    v_mfma_f32_16x16x32_bf16 v[28:31], v[96:99], v[88:91], v[28:31]
    ds_read_b128 v[152:155], v8 offset:33136
    s_waitcnt lgkmcnt(12)
    v_mfma_f32_16x16x32_bf16 v[24:27], v[104:107], v[100:103], v[24:27]
    ds_read_b128 v[156:159], v16 offset:112
    s_waitcnt lgkmcnt(12)
    v_mfma_f32_16x16x32_bf16 v[28:31], v[108:111], v[100:103], v[28:31]
    s_waitcnt lgkmcnt(10)
    v_mfma_f32_16x16x32_bf16 v[24:27], v[116:119], v[112:115], v[24:27]
    s_waitcnt lgkmcnt(9)
    v_mfma_f32_16x16x32_bf16 v[28:31], v[120:123], v[112:115], v[28:31]
    s_waitcnt lgkmcnt(7)
    v_mfma_f32_16x16x32_bf16 v[24:27], v[128:131], v[124:127], v[24:27]
    s_waitcnt lgkmcnt(6)
    v_mfma_f32_16x16x32_bf16 v[28:31], v[132:135], v[124:127], v[28:31]
    s_waitcnt lgkmcnt(4)
    v_mfma_f32_16x16x32_bf16 v[24:27], v[140:143], v[136:139], v[24:27]
    s_waitcnt lgkmcnt(3)
    v_mfma_f32_16x16x32_bf16 v[28:31], v[144:147], v[136:139], v[28:31]
    s_waitcnt lgkmcnt(1)
    v_mfma_f32_16x16x32_bf16 v[24:27], v[152:155], v[148:151], v[24:27]
    s_waitcnt lgkmcnt(0)
    v_mfma_f32_16x16x32_bf16 v[28:31], v[156:159], v[148:151], v[28:31]
    s_nop 5
    v_cvt_pk_bf16_f32 v18, v27, v26
    v_cvt_pk_bf16_f32 v19, v25, v24
    v_alignbit_b32 v20, v19, v18, 16
    ds_write_b64 v14, v[18:19] offset:520
    ds_write_b16 v14, v18 offset:3018
    ds_write_b32 v14, v20 offset:3020
    ds_write_b16_d16_hi v14, v19 offset:3024
    v_cvt_pk_bf16_f32 v18, v31, v30
    v_cvt_pk_bf16_f32 v19, v29, v28
    v_alignbit_b32 v20, v19, v18, 16
    ds_write_b64 v14, v[18:19] offset:8
    ds_write_b16 v14, v18 offset:2506
    ds_write_b32 v14, v20 offset:2508
    ds_write_b16_d16_hi v14, v19 offset:2512
    v_cvt_pk_bf16_f32 v18, 0, v31
    v_cvt_pk_bf16_f32 v19, v31, v31
    s_mov_b32 exec_lo, 0
    s_mov_b32 exec_hi, 0x80000000
    ds_write_b64 v14, v[18:19]
    ds_write_b32 v14, v19 offset:2500
    ds_write_b16 v14, v19 offset:2504
    s_mov_b64 exec, -1
    s_mov_b32 s67, 0x05040100
    s_mov_b32 s68, 0x07060302
    v_lshlrev_b32 v5, 3, v248
    v_add_u32 v5, 118272, v5
    s_waitcnt vmcnt(0)
    v_perm_b32 v232, v242, v240, s67
    v_perm_b32 v233, v246, v244, s67
    ds_write_b64 v5, v[232:233] offset:0
    v_perm_b32 v234, v242, v240, s68
    v_perm_b32 v235, v246, v244, s68
    ds_write_b64 v5, v[234:235] offset:4608
    v_perm_b32 v236, v243, v241, s67
    v_perm_b32 v237, v247, v245, s67
    ds_write_b64 v5, v[236:237] offset:9216
    v_perm_b32 v238, v243, v241, s68
    v_perm_b32 v239, v247, v245, s68
    ds_write_b64 v5, v[238:239] offset:13824
    s_and_b32 s67, s2, 127
    s_lshl_b32 s67, s67, 3
    s_add_u32 s67, s67, s5
    s_mov_b32 s72, 0x800000
    s_lshl_b32 s73, s67, 10
    s_add_u32 s72, s72, s73
    s_add_u32 s73, s72, 0x1000
    s_bitcmp1_b32 s67, 4
    s_cselect_b64 s[68:69], s[20:21], s[18:19]
    s_lshr_b32 s74, s67, 5
    s_lshl_b32 s74, s74, 14
    s_and_b32 s67, s67, 15
    s_lshl_b32 s67, s67, 6
    s_add_u32 s67, s67, s74
    v_lshlrev_b32 v249, 10, v6
    v_lshl_add_u32 v249, v7, 4, v249
    v_add_u32 v249, s67, v249
    v_lshlrev_b32 v250, 4, v1
    s_waitcnt lgkmcnt(0)
    s_barrier
    ds_read2_b32 v[128:129], v11 offset0:0 offset1:1
    ds_read2_b32 v[130:131], v11 offset0:2 offset1:3
    ds_read_b128 v[64:67], v9 offset:480
    ds_read2_b32 v[132:133], v10 offset0:128 offset1:129
    ds_read2_b32 v[134:135], v10 offset0:130 offset1:131
    ds_read2_b32 v[136:137], v10 offset0:0 offset1:1
    ds_read2_b32 v[138:139], v10 offset0:2 offset1:3
    ds_read_b128 v[68:71], v9 offset:992
    ds_read_b128 v[72:75], v9 offset:1504
    ds_read_b128 v[76:79], v9 offset:2016
    ds_read_b128 v[80:83], v9 offset:2528
    ds_read_b128 v[84:87], v9 offset:3040
    s_waitcnt lgkmcnt(9)
    v_mfma_f32_16x16x32_bf16 v[32:35], v[128:131], v[64:67], 0
    global_load_dwordx4 v[212:215], v249, s[68:69] offset:0
    ds_read_b128 v[88:91], v9 offset:3552
    ds_read_b128 v[92:95], v9 offset:4064
    s_waitcnt lgkmcnt(9)
    v_mfma_f32_16x16x32_bf16 v[36:39], v[132:135], v[64:67], 0
    ds_read2_b32 v[140:141], v10 offset0:240 offset1:241
    ds_read2_b32 v[142:143], v10 offset0:242 offset1:243
    s_waitcnt lgkmcnt(9)
    v_mfma_f32_16x16x32_bf16 v[40:43], v[136:139], v[64:67], 0
    ds_read_b128 v[96:99], v9 offset:416
    ds_read2_b32 v[144:145], v10 offset0:112 offset1:113
    ds_read2_b32 v[146:147], v10 offset0:114 offset1:115
    s_waitcnt lgkmcnt(11)
    v_mfma_f32_16x16x32_bf16 v[36:39], v[128:131], v[68:71], v[36:39]
    ds_read_b128 v[100:103], v9 offset:928
    v_mfma_f32_16x16x32_bf16 v[40:43], v[132:135], v[68:71], v[40:43]
    v_mfma_f32_16x16x32_bf16 v[44:47], v[136:139], v[68:71], 0
    s_waitcnt lgkmcnt(11)
    v_mfma_f32_16x16x32_bf16 v[40:43], v[128:131], v[72:75], v[40:43]
    ds_read_b128 v[104:107], v9 offset:1440
    v_mfma_f32_16x16x32_bf16 v[44:47], v[132:135], v[72:75], v[44:47]
    v_mfma_f32_16x16x32_bf16 v[48:51], v[136:139], v[72:75], 0
    s_waitcnt lgkmcnt(11)
    v_mfma_f32_16x16x32_bf16 v[44:47], v[128:131], v[76:79], v[44:47]
    ds_read_b128 v[108:111], v9 offset:1952
    v_mfma_f32_16x16x32_bf16 v[48:51], v[132:135], v[76:79], v[48:51]
    v_mfma_f32_16x16x32_bf16 v[52:55], v[136:139], v[76:79], 0
    s_waitcnt lgkmcnt(11)
    v_mfma_f32_16x16x32_bf16 v[48:51], v[128:131], v[80:83], v[48:51]
    ds_read_b128 v[112:115], v9 offset:2464
    v_mfma_f32_16x16x32_bf16 v[52:55], v[132:135], v[80:83], v[52:55]
    v_mfma_f32_16x16x32_bf16 v[56:59], v[136:139], v[80:83], 0
    s_waitcnt lgkmcnt(11)
    v_mfma_f32_16x16x32_bf16 v[52:55], v[128:131], v[84:87], v[52:55]
    ds_read_b128 v[116:119], v9 offset:2976
    v_mfma_f32_16x16x32_bf16 v[56:59], v[132:135], v[84:87], v[56:59]
    v_mfma_f32_16x16x32_bf16 v[60:63], v[136:139], v[84:87], 0
    s_waitcnt lgkmcnt(11)
    v_mfma_f32_16x16x32_bf16 v[56:59], v[128:131], v[88:91], v[56:59]
    ds_read_b128 v[120:123], v9 offset:3488
    v_mfma_f32_16x16x32_bf16 v[60:63], v[132:135], v[88:91], v[60:63]
    s_waitcnt lgkmcnt(11)
    v_mfma_f32_16x16x32_bf16 v[60:63], v[128:131], v[92:95], v[60:63]
    ds_read_b128 v[124:127], v9 offset:4000
    s_waitcnt lgkmcnt(9)
    v_mfma_f32_16x16x32_bf16 v[32:35], v[140:143], v[96:99], v[32:35]
    ds_read2_b32 v[128:129], v10 offset0:224 offset1:225
    ds_read2_b32 v[130:131], v10 offset0:226 offset1:227
    s_waitcnt lgkmcnt(9)
    v_mfma_f32_16x16x32_bf16 v[36:39], v[144:147], v[96:99], v[36:39]
    ds_read_b128 v[64:67], v9 offset:352
    ds_read2_b32 v[132:133], v10 offset0:96 offset1:97
    ds_read2_b32 v[134:135], v10 offset0:98 offset1:99
    s_waitcnt lgkmcnt(11)
    v_mfma_f32_16x16x32_bf16 v[36:39], v[140:143], v[100:103], v[36:39]
    ds_read_b128 v[68:71], v9 offset:864
    v_mfma_f32_16x16x32_bf16 v[40:43], v[144:147], v[100:103], v[40:43]
    s_waitcnt lgkmcnt(11)
    v_mfma_f32_16x16x32_bf16 v[40:43], v[140:143], v[104:107], v[40:43]
    ds_read_b128 v[72:75], v9 offset:1376
    v_mfma_f32_16x16x32_bf16 v[44:47], v[144:147], v[104:107], v[44:47]
    s_waitcnt lgkmcnt(11)
    v_mfma_f32_16x16x32_bf16 v[44:47], v[140:143], v[108:111], v[44:47]
    ds_read_b128 v[76:79], v9 offset:1888
    v_mfma_f32_16x16x32_bf16 v[48:51], v[144:147], v[108:111], v[48:51]
    s_waitcnt lgkmcnt(11)
    v_mfma_f32_16x16x32_bf16 v[48:51], v[140:143], v[112:115], v[48:51]
    ds_read_b128 v[80:83], v9 offset:2400
    v_mfma_f32_16x16x32_bf16 v[52:55], v[144:147], v[112:115], v[52:55]
    s_waitcnt lgkmcnt(11)
    v_mfma_f32_16x16x32_bf16 v[52:55], v[140:143], v[116:119], v[52:55]
    ds_read_b128 v[84:87], v9 offset:2912
    v_mfma_f32_16x16x32_bf16 v[56:59], v[144:147], v[116:119], v[56:59]
    s_waitcnt lgkmcnt(11)
    v_mfma_f32_16x16x32_bf16 v[56:59], v[140:143], v[120:123], v[56:59]
    ds_read_b128 v[88:91], v9 offset:3424
    v_mfma_f32_16x16x32_bf16 v[60:63], v[144:147], v[120:123], v[60:63]
    s_waitcnt lgkmcnt(11)
    v_mfma_f32_16x16x32_bf16 v[60:63], v[140:143], v[124:127], v[60:63]
    ds_read_b128 v[92:95], v9 offset:3936
    s_waitcnt lgkmcnt(9)
    v_mfma_f32_16x16x32_bf16 v[32:35], v[128:131], v[64:67], v[32:35]
    ds_read2_b32 v[140:141], v10 offset0:208 offset1:209
    ds_read2_b32 v[142:143], v10 offset0:210 offset1:211
    s_waitcnt lgkmcnt(9)
    v_mfma_f32_16x16x32_bf16 v[36:39], v[132:135], v[64:67], v[36:39]
    ds_read_b128 v[96:99], v9 offset:288
    ds_read2_b32 v[144:145], v10 offset0:80 offset1:81
    ds_read2_b32 v[146:147], v10 offset0:82 offset1:83
    s_waitcnt lgkmcnt(11)
    v_mfma_f32_16x16x32_bf16 v[36:39], v[128:131], v[68:71], v[36:39]
    ds_read_b128 v[100:103], v9 offset:800
    v_mfma_f32_16x16x32_bf16 v[40:43], v[132:135], v[68:71], v[40:43]
    s_waitcnt lgkmcnt(11)
    v_mfma_f32_16x16x32_bf16 v[40:43], v[128:131], v[72:75], v[40:43]
    ds_read_b128 v[104:107], v9 offset:1312
    v_mfma_f32_16x16x32_bf16 v[44:47], v[132:135], v[72:75], v[44:47]
    s_waitcnt lgkmcnt(11)
    v_mfma_f32_16x16x32_bf16 v[44:47], v[128:131], v[76:79], v[44:47]
    ds_read_b128 v[108:111], v9 offset:1824
    v_mfma_f32_16x16x32_bf16 v[48:51], v[132:135], v[76:79], v[48:51]
    s_waitcnt lgkmcnt(11)
    v_mfma_f32_16x16x32_bf16 v[48:51], v[128:131], v[80:83], v[48:51]
    ds_read_b128 v[112:115], v9 offset:2336
    v_mfma_f32_16x16x32_bf16 v[52:55], v[132:135], v[80:83], v[52:55]
    s_waitcnt lgkmcnt(11)
    v_mfma_f32_16x16x32_bf16 v[52:55], v[128:131], v[84:87], v[52:55]
    ds_read_b128 v[116:119], v9 offset:2848
    v_mfma_f32_16x16x32_bf16 v[56:59], v[132:135], v[84:87], v[56:59]
    s_waitcnt lgkmcnt(11)
    v_mfma_f32_16x16x32_bf16 v[56:59], v[128:131], v[88:91], v[56:59]
    ds_read_b128 v[120:123], v9 offset:3360
    v_mfma_f32_16x16x32_bf16 v[60:63], v[132:135], v[88:91], v[60:63]
    s_waitcnt lgkmcnt(11)
    v_mfma_f32_16x16x32_bf16 v[60:63], v[128:131], v[92:95], v[60:63]
    ds_read_b128 v[124:127], v9 offset:3872
    s_waitcnt lgkmcnt(9)
    v_mfma_f32_16x16x32_bf16 v[32:35], v[140:143], v[96:99], v[32:35]
    ds_read2_b32 v[128:129], v10 offset0:192 offset1:193
    ds_read2_b32 v[130:131], v10 offset0:194 offset1:195
    s_waitcnt lgkmcnt(9)
    v_mfma_f32_16x16x32_bf16 v[36:39], v[144:147], v[96:99], v[36:39]
    ds_read_b128 v[64:67], v9 offset:224
    ds_read2_b32 v[132:133], v10 offset0:64 offset1:65
    ds_read2_b32 v[134:135], v10 offset0:66 offset1:67
    s_waitcnt lgkmcnt(11)
    v_mfma_f32_16x16x32_bf16 v[36:39], v[140:143], v[100:103], v[36:39]
    ds_read_b128 v[68:71], v9 offset:736
    v_mfma_f32_16x16x32_bf16 v[40:43], v[144:147], v[100:103], v[40:43]
    s_waitcnt lgkmcnt(11)
    v_mfma_f32_16x16x32_bf16 v[40:43], v[140:143], v[104:107], v[40:43]
    ds_read_b128 v[72:75], v9 offset:1248
    v_mfma_f32_16x16x32_bf16 v[44:47], v[144:147], v[104:107], v[44:47]
    s_waitcnt lgkmcnt(11)
    v_mfma_f32_16x16x32_bf16 v[44:47], v[140:143], v[108:111], v[44:47]
    ds_read_b128 v[76:79], v9 offset:1760
    v_mfma_f32_16x16x32_bf16 v[48:51], v[144:147], v[108:111], v[48:51]
    s_waitcnt lgkmcnt(11)
    v_mfma_f32_16x16x32_bf16 v[48:51], v[140:143], v[112:115], v[48:51]
    ds_read_b128 v[80:83], v9 offset:2272
    v_mfma_f32_16x16x32_bf16 v[52:55], v[144:147], v[112:115], v[52:55]
    s_waitcnt lgkmcnt(11)
    v_mfma_f32_16x16x32_bf16 v[52:55], v[140:143], v[116:119], v[52:55]
    ds_read_b128 v[84:87], v9 offset:2784
    v_mfma_f32_16x16x32_bf16 v[56:59], v[144:147], v[116:119], v[56:59]
    s_waitcnt lgkmcnt(11)
    v_mfma_f32_16x16x32_bf16 v[56:59], v[140:143], v[120:123], v[56:59]
    ds_read_b128 v[88:91], v9 offset:3296
    v_mfma_f32_16x16x32_bf16 v[60:63], v[144:147], v[120:123], v[60:63]
    s_waitcnt lgkmcnt(11)
    v_mfma_f32_16x16x32_bf16 v[60:63], v[140:143], v[124:127], v[60:63]
    ds_read_b128 v[92:95], v9 offset:3808
    s_waitcnt lgkmcnt(9)
    v_mfma_f32_16x16x32_bf16 v[32:35], v[128:131], v[64:67], v[32:35]
    s_waitcnt vmcnt(0)
    buffer_store_dwordx4 v[212:215], v250, s[56:59], s72 offen offset:0 sc0 sc1
    ds_read2_b32 v[140:141], v10 offset0:176 offset1:177
    ds_read2_b32 v[142:143], v10 offset0:178 offset1:179
    s_waitcnt lgkmcnt(9)
    v_mfma_f32_16x16x32_bf16 v[36:39], v[132:135], v[64:67], v[36:39]
    ds_read_b128 v[96:99], v9 offset:160
    ds_read2_b32 v[144:145], v10 offset0:48 offset1:49
    ds_read2_b32 v[146:147], v10 offset0:50 offset1:51
    s_waitcnt lgkmcnt(11)
    v_mfma_f32_16x16x32_bf16 v[36:39], v[128:131], v[68:71], v[36:39]
    ds_read_b128 v[100:103], v9 offset:672
    v_mfma_f32_16x16x32_bf16 v[40:43], v[132:135], v[68:71], v[40:43]
    s_waitcnt lgkmcnt(11)
    v_mfma_f32_16x16x32_bf16 v[40:43], v[128:131], v[72:75], v[40:43]
    ds_read_b128 v[104:107], v9 offset:1184
    v_mfma_f32_16x16x32_bf16 v[44:47], v[132:135], v[72:75], v[44:47]
    s_waitcnt lgkmcnt(11)
    v_mfma_f32_16x16x32_bf16 v[44:47], v[128:131], v[76:79], v[44:47]
    ds_read_b128 v[108:111], v9 offset:1696
    v_mfma_f32_16x16x32_bf16 v[48:51], v[132:135], v[76:79], v[48:51]
    s_waitcnt lgkmcnt(11)
    v_mfma_f32_16x16x32_bf16 v[48:51], v[128:131], v[80:83], v[48:51]
    ds_read_b128 v[112:115], v9 offset:2208
    v_mfma_f32_16x16x32_bf16 v[52:55], v[132:135], v[80:83], v[52:55]
    s_waitcnt lgkmcnt(11)
    v_mfma_f32_16x16x32_bf16 v[52:55], v[128:131], v[84:87], v[52:55]
    ds_read_b128 v[116:119], v9 offset:2720
    v_mfma_f32_16x16x32_bf16 v[56:59], v[132:135], v[84:87], v[56:59]
    s_waitcnt lgkmcnt(11)
    v_mfma_f32_16x16x32_bf16 v[56:59], v[128:131], v[88:91], v[56:59]
    ds_read_b128 v[120:123], v9 offset:3232
    v_mfma_f32_16x16x32_bf16 v[60:63], v[132:135], v[88:91], v[60:63]
    s_waitcnt lgkmcnt(11)
    v_mfma_f32_16x16x32_bf16 v[60:63], v[128:131], v[92:95], v[60:63]
    ds_read_b128 v[124:127], v9 offset:3744
    s_waitcnt lgkmcnt(9)
    v_mfma_f32_16x16x32_bf16 v[32:35], v[140:143], v[96:99], v[32:35]
    ds_read2_b32 v[128:129], v10 offset0:160 offset1:161
    ds_read2_b32 v[130:131], v10 offset0:162 offset1:163
    s_waitcnt lgkmcnt(9)
    v_mfma_f32_16x16x32_bf16 v[36:39], v[144:147], v[96:99], v[36:39]
    ds_read_b128 v[64:67], v9 offset:96
    ds_read2_b32 v[132:133], v10 offset0:32 offset1:33
    ds_read2_b32 v[134:135], v10 offset0:34 offset1:35
    s_waitcnt lgkmcnt(11)
    v_mfma_f32_16x16x32_bf16 v[36:39], v[140:143], v[100:103], v[36:39]
    ds_read_b128 v[68:71], v9 offset:608
    v_mfma_f32_16x16x32_bf16 v[40:43], v[144:147], v[100:103], v[40:43]
    s_waitcnt lgkmcnt(11)
    v_mfma_f32_16x16x32_bf16 v[40:43], v[140:143], v[104:107], v[40:43]
    ds_read_b128 v[72:75], v9 offset:1120
    v_mfma_f32_16x16x32_bf16 v[44:47], v[144:147], v[104:107], v[44:47]
    s_waitcnt lgkmcnt(11)
    v_mfma_f32_16x16x32_bf16 v[44:47], v[140:143], v[108:111], v[44:47]
    ds_read_b128 v[76:79], v9 offset:1632
    v_mfma_f32_16x16x32_bf16 v[48:51], v[144:147], v[108:111], v[48:51]
    s_waitcnt lgkmcnt(11)
    v_mfma_f32_16x16x32_bf16 v[48:51], v[140:143], v[112:115], v[48:51]
    ds_read_b128 v[80:83], v9 offset:2144
    v_mfma_f32_16x16x32_bf16 v[52:55], v[144:147], v[112:115], v[52:55]
    s_waitcnt lgkmcnt(11)
    v_mfma_f32_16x16x32_bf16 v[52:55], v[140:143], v[116:119], v[52:55]
    ds_read_b128 v[84:87], v9 offset:2656
    v_mfma_f32_16x16x32_bf16 v[56:59], v[144:147], v[116:119], v[56:59]
    s_waitcnt lgkmcnt(11)
    v_mfma_f32_16x16x32_bf16 v[56:59], v[140:143], v[120:123], v[56:59]
    ds_read_b128 v[88:91], v9 offset:3168
    v_mfma_f32_16x16x32_bf16 v[60:63], v[144:147], v[120:123], v[60:63]
    s_waitcnt lgkmcnt(11)
    v_mfma_f32_16x16x32_bf16 v[60:63], v[140:143], v[124:127], v[60:63]
    ds_read_b128 v[92:95], v9 offset:3680
    s_waitcnt lgkmcnt(9)
    v_mfma_f32_16x16x32_bf16 v[32:35], v[128:131], v[64:67], v[32:35]
    s_waitcnt lgkmcnt(7)
    v_mfma_f32_16x16x32_bf16 v[36:39], v[132:135], v[64:67], v[36:39]
    s_waitcnt lgkmcnt(6)
    v_mfma_f32_16x16x32_bf16 v[36:39], v[128:131], v[68:71], v[36:39]
    v_mfma_f32_16x16x32_bf16 v[40:43], v[132:135], v[68:71], v[40:43]
    s_waitcnt lgkmcnt(5)
    v_mfma_f32_16x16x32_bf16 v[40:43], v[128:131], v[72:75], v[40:43]
    v_mfma_f32_16x16x32_bf16 v[44:47], v[132:135], v[72:75], v[44:47]
    s_waitcnt lgkmcnt(4)
    v_mfma_f32_16x16x32_bf16 v[44:47], v[128:131], v[76:79], v[44:47]
    v_mfma_f32_16x16x32_bf16 v[48:51], v[132:135], v[76:79], v[48:51]
    s_waitcnt lgkmcnt(3)
    v_mfma_f32_16x16x32_bf16 v[48:51], v[128:131], v[80:83], v[48:51]
    v_mfma_f32_16x16x32_bf16 v[52:55], v[132:135], v[80:83], v[52:55]
    s_waitcnt lgkmcnt(2)
    v_mfma_f32_16x16x32_bf16 v[52:55], v[128:131], v[84:87], v[52:55]
    v_mfma_f32_16x16x32_bf16 v[56:59], v[132:135], v[84:87], v[56:59]
    s_waitcnt lgkmcnt(1)
    v_mfma_f32_16x16x32_bf16 v[56:59], v[128:131], v[88:91], v[56:59]
    v_mfma_f32_16x16x32_bf16 v[60:63], v[132:135], v[88:91], v[60:63]
    s_waitcnt lgkmcnt(0)
    v_mfma_f32_16x16x32_bf16 v[60:63], v[128:131], v[92:95], v[60:63]
    s_lshl_b32 s65, s5, 12
    v_lshl_add_u32 v2, v1, 4, s65
    ds_write_b128 v2, v[48:51] offset:0
    ds_write_b128 v2, v[52:55] offset:1024
    s_nop 0
    ds_write_b128 v2, v[56:59] offset:2048
    s_nop 1
    ds_write_b128 v2, v[60:63] offset:3072
    s_nop 0
    s_branch L_cvJ_3
L_cvB_2:
    v_add_u32 v16, 84624, v8
    v_and_b32 v2, 3, v6
    v_lshlrev_b32 v2, 6, v2
    v_lshrrev_b32 v3, 2, v6
    v_lshlrev_b32 v3, 4, v3
    v_sub_u32 v2, v2, v3
    v_add_u32 v2, 652, v2
    v_and_b32 v3, 1, v6
    v_mul_u32_u24 v3, 80, v3
    v_lshrrev_b32 v4, 1, v6
    v_lshlrev_b32 v4, 4, v4
    v_sub_u32 v3, v3, v4
    v_add_u32 v3, 988, v3
    v_cmp_gt_u32 vcc, 8, v6
    s_nop 1
    v_cndmask_b32 v2, v3, v2, vcc
    v_lshlrev_b32 v3, 2, v7
    v_sub_u32 v2, v2, v3
    v_lshl_add_u32 v14, v2, 1, s62
    v_mov_b32 v17, s62
    s_waitcnt lgkmcnt(0)
    s_barrier
    ds_read_b128 v[140:143], v8 offset:0
    ds_read_b128 v[144:147], v16 offset:0
    ds_read_b128 v[148:151], v8 offset:16
    ds_read_b128 v[152:155], v16 offset:16
    ds_read_b128 v[156:159], v8 offset:32
    ds_read_b128 v[160:163], v16 offset:32
    ds_read_b128 v[164:167], v8 offset:48
    ds_read_b128 v[168:171], v16 offset:48
    ds_read_b128 v[172:175], v8 offset:64
    ds_read_b128 v[176:179], v16 offset:64
    ds_read_b128 v[180:183], v8 offset:80
    ds_read_b128 v[184:187], v16 offset:80
    ds_read_b128 v[188:191], v8 offset:96
    ds_read_b128 v[192:195], v16 offset:96
    s_waitcnt lgkmcnt(12)
    v_mfma_f32_16x16x32_bf16 v[24:27], v[140:143], v[144:147], 0
    ds_read_b128 v[196:199], v8 offset:112
    ds_read_b128 v[200:203], v16 offset:112
    s_waitcnt lgkmcnt(12)
    v_mfma_f32_16x16x32_bf16 v[24:27], v[148:151], v[152:155], v[24:27]
    s_waitcnt lgkmcnt(10)
    v_mfma_f32_16x16x32_bf16 v[24:27], v[156:159], v[160:163], v[24:27]
    s_waitcnt lgkmcnt(8)
    v_mfma_f32_16x16x32_bf16 v[24:27], v[164:167], v[168:171], v[24:27]
    s_waitcnt lgkmcnt(6)
    v_mfma_f32_16x16x32_bf16 v[24:27], v[172:175], v[176:179], v[24:27]
    s_waitcnt lgkmcnt(4)
    v_mfma_f32_16x16x32_bf16 v[24:27], v[180:183], v[184:187], v[24:27]
    s_waitcnt lgkmcnt(2)
    v_mfma_f32_16x16x32_bf16 v[24:27], v[188:191], v[192:195], v[24:27]
    s_waitcnt lgkmcnt(0)
    v_mfma_f32_16x16x32_bf16 v[24:27], v[196:199], v[200:203], v[24:27]
    ds_read2_b32 v[64:65], v12 offset0:0 offset1:1
    ds_read2_b32 v[66:67], v12 offset0:2 offset1:3
    ds_read2_b32 v[68:69], v12 offset0:27 offset1:28
    ds_read2_b32 v[70:71], v12 offset0:29 offset1:30
    ds_read2_b32 v[72:73], v12 offset0:52 offset1:53
    ds_read2_b32 v[74:75], v12 offset0:54 offset1:55
    ds_read2_b32 v[76:77], v12 offset0:77 offset1:78
    ds_read2_b32 v[78:79], v12 offset0:79 offset1:80
    v_cvt_pk_bf16_f32 v18, v27, v26
    v_cvt_pk_bf16_f32 v19, v25, v24
    v_alignbit_b32 v20, v19, v18, 16
    ds_write_b64 v14, v[18:19] offset:0
    ds_write_b16 v14, v18 offset:2498
    ds_write_b32 v14, v20 offset:2500
    ds_write_b16_d16_hi v14, v19 offset:2504
    v_cvt_pk_bf16_f32 v19, v27, v27
    s_mov_b32 exec_lo, 0
    s_mov_b32 exec_hi, 0x00800000
    ds_write_b16 v17, v19 offset:1174
    ds_write_b16 v17, v19 offset:1176
    ds_write_b32 v17, v19 offset:3672
    s_mov_b64 exec, -1
    s_mov_b32 s67, 0x05040100
    s_mov_b32 s68, 0x07060302
    v_lshlrev_b32 v5, 3, v248
    v_add_u32 v5, 118272, v5
    s_waitcnt vmcnt(0)
    v_perm_b32 v232, v242, v240, s67
    v_perm_b32 v233, v246, v244, s67
    ds_write_b64 v5, v[232:233] offset:0
    v_perm_b32 v234, v242, v240, s68
    v_perm_b32 v235, v246, v244, s68
    ds_write_b64 v5, v[234:235] offset:4608
    v_perm_b32 v236, v243, v241, s67
    v_perm_b32 v237, v247, v245, s67
    ds_write_b64 v5, v[236:237] offset:9216
    v_perm_b32 v238, v243, v241, s68
    v_perm_b32 v239, v247, v245, s68
    ds_write_b64 v5, v[238:239] offset:13824
    s_and_b32 s67, s2, 127
    s_lshl_b32 s67, s67, 3
    s_add_u32 s67, s67, s5
    s_mov_b32 s72, 0x800000
    s_lshl_b32 s73, s67, 10
    s_add_u32 s72, s72, s73
    s_add_u32 s73, s72, 0x1000
    s_bitcmp1_b32 s67, 4
    s_cselect_b64 s[68:69], s[20:21], s[18:19]
    s_lshr_b32 s74, s67, 5
    s_lshl_b32 s74, s74, 14
    s_and_b32 s67, s67, 15
    s_lshl_b32 s67, s67, 6
    s_add_u32 s67, s67, s74
    v_lshlrev_b32 v249, 10, v6
    v_lshl_add_u32 v249, v7, 4, v249
    v_add_u32 v249, s67, v249
    v_lshlrev_b32 v250, 4, v1
    s_waitcnt lgkmcnt(0)
    s_barrier
    ds_read_b128 v[124:127], v9 offset:480
    ds_read_b128 v[128:131], v9 offset:464
    ds_read2_b32 v[120:121], v11 offset0:24 offset1:25
    ds_read2_b32 v[122:123], v11 offset0:26 offset1:27
    ds_read_b128 v[132:135], v9 offset:992
    ds_read_b128 v[136:139], v9 offset:976
    ds_read2_b32 v[80:81], v13 offset0:16 offset1:17
    ds_read2_b32 v[82:83], v13 offset0:48 offset1:49
    ds_read2_b32 v[84:85], v13 offset0:80 offset1:81
    ds_read2_b32 v[86:87], v13 offset0:112 offset1:113
    ds_read2_b32 v[88:89], v13 offset0:8 offset1:9
    ds_read2_b32 v[90:91], v13 offset0:40 offset1:41
    s_waitcnt lgkmcnt(11)
    v_mfma_f32_16x16x32_bf16 v[140:143], v[124:127], v[64:67], 0
    global_load_dwordx4 v[212:215], v249, s[68:69] offset:0
    v_mfma_f32_16x16x32_bf16 v[144:147], v[124:127], v[68:71], 0
    s_waitcnt lgkmcnt(10)
    v_mfma_f32_16x16x32_bf16 v[148:151], v[128:131], v[64:67], 0
    ds_read2_b32 v[92:93], v13 offset0:72 offset1:73
    ds_read2_b32 v[94:95], v13 offset0:104 offset1:105
    v_mfma_f32_16x16x32_bf16 v[152:155], v[128:131], v[68:71], 0
    v_mfma_f32_16x16x32_bf16 v[156:159], v[124:127], v[72:75], 0
    v_mfma_f32_16x16x32_bf16 v[160:163], v[128:131], v[76:79], 0
    s_waitcnt lgkmcnt(10)
    v_mfma_f32_16x16x32_bf16 v[48:51], v[120:123], v[124:127], 0
    ds_read2_b32 v[96:97], v13 offset0:0 offset1:1
    ds_read2_b32 v[98:99], v13 offset0:32 offset1:33
    s_waitcnt lgkmcnt(11)
    v_mfma_f32_16x16x32_bf16 v[164:167], v[132:135], v[64:67], 0
    v_mfma_f32_16x16x32_bf16 v[168:171], v[132:135], v[68:71], 0
    s_waitcnt lgkmcnt(10)
    v_mfma_f32_16x16x32_bf16 v[172:175], v[136:139], v[64:67], 0
    ds_read2_b32 v[100:101], v13 offset0:64 offset1:65
    ds_read2_b32 v[102:103], v13 offset0:96 offset1:97
    v_mfma_f32_16x16x32_bf16 v[176:179], v[136:139], v[68:71], 0
    v_mfma_f32_16x16x32_bf16 v[180:183], v[132:135], v[72:75], 0
    v_mfma_f32_16x16x32_bf16 v[184:187], v[136:139], v[76:79], 0
    v_mfma_f32_16x16x32_bf16 v[52:55], v[120:123], v[132:135], 0
    v_cvt_pk_bf16_f32 v188, v140, v141
    v_cvt_pk_bf16_f32 v189, v142, v143
    v_cvt_pk_bf16_f32 v190, v144, v145
    v_cvt_pk_bf16_f32 v191, v146, v147
    v_cvt_pk_bf16_f32 v192, v148, v149
    v_cvt_pk_bf16_f32 v193, v150, v151
    v_cvt_pk_bf16_f32 v194, v152, v153
    v_cvt_pk_bf16_f32 v195, v154, v155
    v_cvt_pk_bf16_f32 v196, v156, v157
    v_cvt_pk_bf16_f32 v197, v158, v159
    v_cvt_pk_bf16_f32 v198, v160, v161
    v_cvt_pk_bf16_f32 v199, v162, v163
    s_waitcnt lgkmcnt(10)
    v_mfma_f32_16x16x32_bf16 v[40:43], v[188:191], v[80:83], 0
    ds_read2_b32 v[104:105], v13 offset0:152 offset1:153
    ds_read2_b32 v[106:107], v13 offset0:192 offset1:193
    v_cvt_pk_bf16_f32 v200, v164, v165
    v_cvt_pk_bf16_f32 v201, v166, v167
    s_waitcnt lgkmcnt(10)
    v_mfma_f32_16x16x32_bf16 v[40:43], v[192:195], v[84:87], v[40:43]
    ds_read2_b32 v[108:109], v13 offset0:144 offset1:145
    ds_read2_b32 v[110:111], v13 offset0:184 offset1:185
    v_cvt_pk_bf16_f32 v202, v168, v169
    v_cvt_pk_bf16_f32 v203, v170, v171
    s_waitcnt lgkmcnt(10)
    v_mfma_f32_16x16x32_bf16 v[44:47], v[188:191], v[88:91], 0
    ds_read2_b32 v[112:113], v13 offset0:136 offset1:137
    ds_read2_b32 v[114:115], v13 offset0:176 offset1:177
    v_cvt_pk_bf16_f32 v204, v172, v173
    v_cvt_pk_bf16_f32 v205, v174, v175
    s_waitcnt lgkmcnt(10)
    v_mfma_f32_16x16x32_bf16 v[44:47], v[192:195], v[92:95], v[44:47]
    ds_read2_b32 v[116:117], v13 offset0:128 offset1:129
    ds_read2_b32 v[118:119], v13 offset0:168 offset1:169
    v_cvt_pk_bf16_f32 v206, v176, v177
    v_cvt_pk_bf16_f32 v207, v178, v179
    s_waitcnt lgkmcnt(10)
    v_mfma_f32_16x16x32_bf16 v[48:51], v[188:191], v[96:99], v[48:51]
    ds_read_b128 v[124:127], v9 offset:1504
    ds_read_b128 v[128:131], v9 offset:1488
    v_cvt_pk_bf16_f32 v208, v180, v181
    v_cvt_pk_bf16_f32 v209, v182, v183
    s_waitcnt lgkmcnt(10)
    v_mfma_f32_16x16x32_bf16 v[48:51], v[192:195], v[100:103], v[48:51]
    ds_read_b128 v[132:135], v9 offset:2016
    ds_read_b128 v[136:139], v9 offset:2000
    v_cvt_pk_bf16_f32 v210, v184, v185
    v_cvt_pk_bf16_f32 v211, v186, v187
    s_waitcnt lgkmcnt(10)
    v_mfma_f32_16x16x32_bf16 v[48:51], v[196:199], v[104:107], v[48:51]
    s_waitcnt lgkmcnt(8)
    v_mfma_f32_16x16x32_bf16 v[52:55], v[196:199], v[108:111], v[52:55]
    s_waitcnt lgkmcnt(6)
    v_mfma_f32_16x16x32_bf16 v[56:59], v[196:199], v[112:115], 0
    s_waitcnt lgkmcnt(4)
    v_mfma_f32_16x16x32_bf16 v[60:63], v[196:199], v[116:119], 0
    s_waitcnt lgkmcnt(3)
    v_mfma_f32_16x16x32_bf16 v[140:143], v[124:127], v[64:67], 0
    v_mfma_f32_16x16x32_bf16 v[144:147], v[124:127], v[68:71], 0
    s_waitcnt lgkmcnt(2)
    v_mfma_f32_16x16x32_bf16 v[148:151], v[128:131], v[64:67], 0
    v_mfma_f32_16x16x32_bf16 v[152:155], v[128:131], v[68:71], 0
    v_mfma_f32_16x16x32_bf16 v[156:159], v[124:127], v[72:75], 0
    v_mfma_f32_16x16x32_bf16 v[160:163], v[128:131], v[76:79], 0
    v_mfma_f32_16x16x32_bf16 v[56:59], v[120:123], v[124:127], v[56:59]
    ds_read_b128 v[124:127], v9 offset:2528
    ds_read_b128 v[128:131], v9 offset:2512
    v_mfma_f32_16x16x32_bf16 v[44:47], v[200:203], v[80:83], v[44:47]
    v_cvt_pk_bf16_f32 v188, v140, v141
    v_cvt_pk_bf16_f32 v189, v142, v143
    v_mfma_f32_16x16x32_bf16 v[44:47], v[204:207], v[84:87], v[44:47]
    v_cvt_pk_bf16_f32 v190, v144, v145
    v_cvt_pk_bf16_f32 v191, v146, v147
    v_mfma_f32_16x16x32_bf16 v[48:51], v[200:203], v[88:91], v[48:51]
    v_cvt_pk_bf16_f32 v192, v148, v149
    v_cvt_pk_bf16_f32 v193, v150, v151
    v_mfma_f32_16x16x32_bf16 v[48:51], v[204:207], v[92:95], v[48:51]
    v_cvt_pk_bf16_f32 v194, v152, v153
    v_cvt_pk_bf16_f32 v195, v154, v155
    v_mfma_f32_16x16x32_bf16 v[52:55], v[200:203], v[96:99], v[52:55]
    v_cvt_pk_bf16_f32 v196, v156, v157
    v_cvt_pk_bf16_f32 v197, v158, v159
    v_mfma_f32_16x16x32_bf16 v[52:55], v[204:207], v[100:103], v[52:55]
    v_cvt_pk_bf16_f32 v198, v160, v161
    v_cvt_pk_bf16_f32 v199, v162, v163
    v_mfma_f32_16x16x32_bf16 v[52:55], v[208:211], v[104:107], v[52:55]
    v_mfma_f32_16x16x32_bf16 v[56:59], v[208:211], v[108:111], v[56:59]
    v_mfma_f32_16x16x32_bf16 v[60:63], v[208:211], v[112:115], v[60:63]
    s_waitcnt lgkmcnt(3)
    v_mfma_f32_16x16x32_bf16 v[164:167], v[132:135], v[64:67], 0
    v_mfma_f32_16x16x32_bf16 v[168:171], v[132:135], v[68:71], 0
    s_waitcnt lgkmcnt(2)
    v_mfma_f32_16x16x32_bf16 v[172:175], v[136:139], v[64:67], 0
    v_mfma_f32_16x16x32_bf16 v[176:179], v[136:139], v[68:71], 0
    v_mfma_f32_16x16x32_bf16 v[180:183], v[132:135], v[72:75], 0
    v_mfma_f32_16x16x32_bf16 v[184:187], v[136:139], v[76:79], 0
    v_mfma_f32_16x16x32_bf16 v[60:63], v[120:123], v[132:135], v[60:63]
    ds_read_b128 v[132:135], v9 offset:3040
    ds_read_b128 v[136:139], v9 offset:3024
    v_mfma_f32_16x16x32_bf16 v[48:51], v[188:191], v[80:83], v[48:51]
    v_cvt_pk_bf16_f32 v200, v164, v165
    v_cvt_pk_bf16_f32 v201, v166, v167
    v_mfma_f32_16x16x32_bf16 v[48:51], v[192:195], v[84:87], v[48:51]
    v_cvt_pk_bf16_f32 v202, v168, v169
    v_cvt_pk_bf16_f32 v203, v170, v171
    v_mfma_f32_16x16x32_bf16 v[52:55], v[188:191], v[88:91], v[52:55]
    v_cvt_pk_bf16_f32 v204, v172, v173
    v_cvt_pk_bf16_f32 v205, v174, v175
    v_mfma_f32_16x16x32_bf16 v[52:55], v[192:195], v[92:95], v[52:55]
    v_cvt_pk_bf16_f32 v206, v176, v177
    v_cvt_pk_bf16_f32 v207, v178, v179
    v_mfma_f32_16x16x32_bf16 v[56:59], v[188:191], v[96:99], v[56:59]
    v_cvt_pk_bf16_f32 v208, v180, v181
    v_cvt_pk_bf16_f32 v209, v182, v183
    v_mfma_f32_16x16x32_bf16 v[56:59], v[192:195], v[100:103], v[56:59]
    v_cvt_pk_bf16_f32 v210, v184, v185
    v_cvt_pk_bf16_f32 v211, v186, v187
    v_mfma_f32_16x16x32_bf16 v[56:59], v[196:199], v[104:107], v[56:59]
    v_mfma_f32_16x16x32_bf16 v[60:63], v[196:199], v[108:111], v[60:63]
    s_waitcnt vmcnt(0)
    buffer_store_dwordx4 v[212:215], v250, s[56:59], s72 offen offset:0 sc0 sc1
    s_waitcnt lgkmcnt(3)
    v_mfma_f32_16x16x32_bf16 v[140:143], v[124:127], v[64:67], 0
    v_mfma_f32_16x16x32_bf16 v[144:147], v[124:127], v[68:71], 0
    s_waitcnt lgkmcnt(2)
    v_mfma_f32_16x16x32_bf16 v[148:151], v[128:131], v[64:67], 0
    v_mfma_f32_16x16x32_bf16 v[152:155], v[128:131], v[68:71], 0
    v_mfma_f32_16x16x32_bf16 v[52:55], v[200:203], v[80:83], v[52:55]
    s_nop 2
    v_cvt_pk_bf16_f32 v188, v140, v141
    v_cvt_pk_bf16_f32 v189, v142, v143
    v_mfma_f32_16x16x32_bf16 v[52:55], v[204:207], v[84:87], v[52:55]
    v_cvt_pk_bf16_f32 v190, v144, v145
    v_cvt_pk_bf16_f32 v191, v146, v147
    v_mfma_f32_16x16x32_bf16 v[56:59], v[200:203], v[88:91], v[56:59]
    v_cvt_pk_bf16_f32 v192, v148, v149
    v_cvt_pk_bf16_f32 v193, v150, v151
    v_mfma_f32_16x16x32_bf16 v[56:59], v[204:207], v[92:95], v[56:59]
    v_cvt_pk_bf16_f32 v194, v152, v153
    v_cvt_pk_bf16_f32 v195, v154, v155
    v_mfma_f32_16x16x32_bf16 v[60:63], v[200:203], v[96:99], v[60:63]
    v_mfma_f32_16x16x32_bf16 v[60:63], v[204:207], v[100:103], v[60:63]
    v_mfma_f32_16x16x32_bf16 v[60:63], v[208:211], v[104:107], v[60:63]
    s_waitcnt lgkmcnt(1)
    v_mfma_f32_16x16x32_bf16 v[164:167], v[132:135], v[64:67], 0
    v_mfma_f32_16x16x32_bf16 v[168:171], v[132:135], v[68:71], 0
    s_waitcnt lgkmcnt(0)
    v_mfma_f32_16x16x32_bf16 v[172:175], v[136:139], v[64:67], 0
    v_mfma_f32_16x16x32_bf16 v[176:179], v[136:139], v[68:71], 0
    v_mfma_f32_16x16x32_bf16 v[56:59], v[188:191], v[80:83], v[56:59]
    s_nop 2
    v_cvt_pk_bf16_f32 v200, v164, v165
    v_cvt_pk_bf16_f32 v201, v166, v167
    v_mfma_f32_16x16x32_bf16 v[56:59], v[192:195], v[84:87], v[56:59]
    v_cvt_pk_bf16_f32 v202, v168, v169
    v_cvt_pk_bf16_f32 v203, v170, v171
    v_mfma_f32_16x16x32_bf16 v[60:63], v[188:191], v[88:91], v[60:63]
    v_cvt_pk_bf16_f32 v204, v172, v173
    v_cvt_pk_bf16_f32 v205, v174, v175
    v_mfma_f32_16x16x32_bf16 v[60:63], v[192:195], v[92:95], v[60:63]
    v_cvt_pk_bf16_f32 v206, v176, v177
    v_cvt_pk_bf16_f32 v207, v178, v179
    v_mfma_f32_16x16x32_bf16 v[60:63], v[200:203], v[80:83], v[60:63]
    s_nop 0
    v_mfma_f32_16x16x32_bf16 v[60:63], v[204:207], v[84:87], v[60:63]
    ds_read2_b32 v[128:129], v10 offset0:144 offset1:145
    ds_read2_b32 v[130:131], v10 offset0:146 offset1:147
    ds_read_b128 v[64:67], v9 offset:32
    ds_read2_b32 v[132:133], v10 offset0:16 offset1:17
    ds_read2_b32 v[134:135], v10 offset0:18 offset1:19
    ds_read_b128 v[68:71], v9 offset:544
    ds_read_b128 v[72:75], v9 offset:1056
    ds_read_b128 v[76:79], v9 offset:1568
    ds_read_b128 v[80:83], v9 offset:2080
    ds_read_b128 v[84:87], v9 offset:2592
    ds_read_b128 v[88:91], v9 offset:3104
    ds_read_b128 v[92:95], v9 offset:3616
    s_waitcnt lgkmcnt(9)
    v_mfma_f32_16x16x32_bf16 v[32:35], v[128:131], v[64:67], 0
    s_waitcnt lgkmcnt(7)
    v_mfma_f32_16x16x32_bf16 v[36:39], v[132:135], v[64:67], 0
    s_waitcnt lgkmcnt(6)
    v_mfma_f32_16x16x32_bf16 v[36:39], v[128:131], v[68:71], v[36:39]
    v_mfma_f32_16x16x32_bf16 v[40:43], v[132:135], v[68:71], v[40:43]
    s_waitcnt lgkmcnt(5)
    v_mfma_f32_16x16x32_bf16 v[40:43], v[128:131], v[72:75], v[40:43]
    v_mfma_f32_16x16x32_bf16 v[44:47], v[132:135], v[72:75], v[44:47]
    s_waitcnt lgkmcnt(4)
    v_mfma_f32_16x16x32_bf16 v[44:47], v[128:131], v[76:79], v[44:47]
    v_mfma_f32_16x16x32_bf16 v[48:51], v[132:135], v[76:79], v[48:51]
    s_waitcnt lgkmcnt(3)
    v_mfma_f32_16x16x32_bf16 v[48:51], v[128:131], v[80:83], v[48:51]
    v_mfma_f32_16x16x32_bf16 v[52:55], v[132:135], v[80:83], v[52:55]
    s_waitcnt lgkmcnt(2)
    v_mfma_f32_16x16x32_bf16 v[52:55], v[128:131], v[84:87], v[52:55]
    v_mfma_f32_16x16x32_bf16 v[56:59], v[132:135], v[84:87], v[56:59]
    s_waitcnt lgkmcnt(1)
    v_mfma_f32_16x16x32_bf16 v[56:59], v[128:131], v[88:91], v[56:59]
    v_mfma_f32_16x16x32_bf16 v[60:63], v[132:135], v[88:91], v[60:63]
    s_waitcnt lgkmcnt(0)
    v_mfma_f32_16x16x32_bf16 v[60:63], v[128:131], v[92:95], v[60:63]
    s_lshl_b32 s65, s5, 12
    v_lshl_add_u32 v2, v1, 4, s65
    ds_write_b128 v2, v[32:35] offset:0
    ds_write_b128 v2, v[36:39] offset:1024
    ds_write_b128 v2, v[40:43] offset:2048
    ds_write_b128 v2, v[44:47] offset:3072
    v_mov_b32 v32, v48
    v_mov_b32 v33, v49
    v_mov_b32 v34, v50
    v_mov_b32 v35, v51
    v_mov_b32 v36, v52
    v_mov_b32 v37, v53
    v_mov_b32 v38, v54
    v_mov_b32 v39, v55
    v_mov_b32 v40, v56
    v_mov_b32 v41, v57
    v_mov_b32 v42, v58
    v_mov_b32 v43, v59
    v_mov_b32 v44, v60
    v_mov_b32 v45, v61
    v_mov_b32 v46, v62
    v_mov_b32 v47, v63
L_cvJ_3:
    v_xor_b32 v2, 0x4000, v2
    v_lshlrev_b32 v3, 5, v6
    v_lshl_add_u32 v3, v7, 3, v3
    s_lshl_b32 s65, s4, 12
    s_lshl_b32 s66, s7, 11
    s_add_u32 s65, s65, s66
    s_add_u32 s65, s65, 0x600000
    s_waitcnt lgkmcnt(0)
    s_barrier
    ds_read_b128 v[64:67], v2 offset:0
    ds_read_b128 v[68:71], v2 offset:1024
    ds_read_b128 v[72:75], v2 offset:2048
    ds_read_b128 v[76:79], v2 offset:3072
    s_waitcnt lgkmcnt(3)
    v_add_f32 v64, v64, v32
    v_add_f32 v65, v65, v33
    v_add_f32 v66, v66, v34
    v_add_f32 v67, v67, v35
    v_cvt_pk_bf16_f32 v64, v64, v65
    v_cvt_pk_bf16_f32 v65, v66, v67
    buffer_store_dwordx2 v[64:65], v3, s[56:59], s65 offen offset:0 sc0 sc1
    s_waitcnt lgkmcnt(2)
    v_add_f32 v68, v68, v36
    v_add_f32 v69, v69, v37
    v_add_f32 v70, v70, v38
    v_add_f32 v71, v71, v39
    v_cvt_pk_bf16_f32 v68, v68, v69
    v_cvt_pk_bf16_f32 v69, v70, v71
    buffer_store_dwordx2 v[68:69], v3, s[56:59], s65 offen offset:512 sc0 sc1
    s_waitcnt lgkmcnt(1)
    v_add_f32 v72, v72, v40
    v_add_f32 v73, v73, v41
    v_add_f32 v74, v74, v42
    v_add_f32 v75, v75, v43
    v_cvt_pk_bf16_f32 v72, v72, v73
    v_cvt_pk_bf16_f32 v73, v74, v75
    buffer_store_dwordx2 v[72:73], v3, s[56:59], s65 offen offset:1024 sc0 sc1
    s_waitcnt lgkmcnt(0)
    v_add_f32 v76, v76, v44
    v_add_f32 v77, v77, v45
    v_add_f32 v78, v78, v46
    v_add_f32 v79, v79, v47
    v_cvt_pk_bf16_f32 v76, v76, v77
    v_cvt_pk_bf16_f32 v77, v78, v79
    buffer_store_dwordx2 v[76:77], v3, s[56:59], s65 offen offset:1536 sc0 sc1
L_end1:
    s_endpgm
.globl mix_b_kernel
.p2align 8
.type mix_b_kernel,@function
mix_b_kernel:
    s_load_dwordx16 s[8:23], s[0:1], 0
    s_load_dwordx16 s[24:39], s[0:1], 64
    s_load_dwordx8 s[40:47], s[0:1], 128
    s_load_dwordx4 s[48:51], s[0:1], 160
    s_cmp_ge_u32 s2, 256
    s_cbranch_scc1 L_end2_1001
    s_and_b32 s3, s2, 7
    s_lshl_b32 s3, s3, 2
    s_lshr_b32 s4, s2, 6
    s_add_u32 s3, s3, s4
    s_bfe_u32 s4, s2, 0x30003
    s_lshr_b32 s6, s3, 1
    v_and_b32 v1, 63, v0
    v_lshrrev_b32 v2, 6, v0
    s_nop 0
    v_readfirstlane_b32 s5, v2
    v_and_b32 v3, 0x1e3, v0
    v_bfe_u32 v2, v0, 2, 2
    v_lshl_or_b32 v3, v2, 3, v3
    v_bfe_u32 v2, v0, 4, 1
    v_lshl_or_b32 v3, v2, 2, v3
    v_lshlrev_b32 v2, 1, v3
    v_lshlrev_b32 v3, 4, v3
    v_lshlrev_b32 v4, 4, v1
    s_lshl_b32 s60, s3, 17
    s_and_b32 s7, s5, 1
    s_bfe_u32 s75, s5, 0x10001
    s_lshr_b32 s61, s5, 2
    s_lshl_b32 s62, s4, 1
    s_add_u32 s62, s62, s7
    s_lshl_b32 s63, s62, 16
    s_lshl_b32 s64, s61, 13
    s_add_u32 s63, s63, s64
    s_lshl_b32 s64, s75, 14
    s_add_u32 s63, s63, s64
    s_add_u32 s63, s63, 0x800000
    s_add_u32 s72, s63, 0x8000
    s_waitcnt lgkmcnt(0)
    s_mov_b32 s52, s50
    s_mov_b32 s53, s51
    s_mov_b32 s54, 0x1000000
    s_mov_b32 s55, 0x00020000
    global_load_ushort v8, v2, s[10:11]
    global_load_ushort v9, v2, s[12:13]
    global_load_ushort v10, v2, s[22:23]
    s_cmp_le_u32 s6, 0
    s_cbranch_scc1 L_noE_1002
    s_mov_b32 s64, 0x400000
    buffer_load_dwordx4 v[12:15], v3, s[52:55], s64 offen
    s_cmp_le_u32 s6, 4
    s_cbranch_scc1 L_noE_1002
    s_mov_b32 s64, 0x402000
    buffer_load_dwordx4 v[16:19], v3, s[52:55], s64 offen
    s_cmp_le_u32 s6, 8
    s_cbranch_scc1 L_noE_1002
    s_mov_b32 s64, 0x404000
    buffer_load_dwordx4 v[20:23], v3, s[52:55], s64 offen
    s_cmp_le_u32 s6, 12
    s_cbranch_scc1 L_noE_1002
    s_mov_b32 s64, 0x406000
    buffer_load_dwordx4 v[24:27], v3, s[52:55], s64 offen
L_noE_1002:
    s_add_u32 s64, s60, 0
    s_add_u32 s65, s60, 65536
    buffer_load_dwordx4 v[64:67], v3, s[52:55], s64 offen
    buffer_load_dwordx4 v[68:71], v3, s[52:55], s65 offen
    s_add_u32 s64, s60, 8192
    s_add_u32 s65, s60, 73728
    buffer_load_dwordx4 v[72:75], v3, s[52:55], s64 offen
    buffer_load_dwordx4 v[76:79], v3, s[52:55], s65 offen
    v_and_b32 v5, 15, v1
    v_lshrrev_b32 v6, 4, v1
    s_lshl_b32 s66, s3, 6
    s_lshl_b32 s67, s75, 5
    s_add_u32 s66, s66, s67
    s_lshl_b32 s67, s62, 5
    s_lshl_b32 s68, s66, 10
    s_lshl_b32 s69, s67, 1
    s_add_u32 s68, s68, s69
    v_lshlrev_b32 v7, 10, v5
    v_lshl_add_u32 v7, v6, 4, v7
    v_add_u32 v220, s68, v7
    v_add_u32 v221, 0x4000, v220
    s_lshl_b32 s68, s67, 12
    s_lshl_b32 s69, s66, 1
    s_add_u32 s68, s68, s69
    s_add_u32 s73, s68, 0x600000
    v_lshlrev_b32 v7, 12, v5
    v_lshl_add_u32 v222, v6, 4, v7
    s_lshl_b32 s68, s66, 2
    s_add_u32 s74, s68, 0x410000
    v_lshlrev_b32 v223, 2, v5
    v_add_u32 v7, s67, v5
    v_lshlrev_b32 v224, 1, v7
    s_mov_b32 s56, s46
    s_mov_b32 s57, s47
    s_mov_b32 s58, 0x400000
    s_mov_b32 s59, 0x00020000
    v_lshlrev_b32 v213, 11, v5
    v_lshl_add_u32 v213, v6, 4, v213
    s_lshl_b32 s70, s66, 11
    s_lshl_b32 s71, s67, 2
    s_add_u32 s70, s70, s71
    v_and_b32 v7, 7, v0
    v_and_b32 v28, 255, v0
    v_lshlrev_b32 v28, 7, v28
    v_lshl_or_b32 v28, v7, 4, v28
    v_lshl_or_b32 v28, s61, 16, v28
    v_lshrrev_b32 v7, 2, v1
    v_and_b32 v11, 7, v7
    v_bfe_u32 v29, v1, 1, 1
    v_xor_b32 v11, v11, v29
    v_lshlrev_b32 v7, 7, v7
    v_lshl_or_b32 v7, v11, 4, v7
    v_and_b32 v11, 1, v1
    v_lshl_or_b32 v7, v11, 3, v7
    s_lshl_b32 s64, s61, 16
    s_mul_i32 s65, s75, 0x8040
    s_add_u32 s64, s64, s65
    v_xor_b32 v7, s64, v7
    s_and_b32 s64, s5, 3
    s_lshl_b32 s64, s64, 13
    s_add_u32 s64, s64, 0x20000
    v_add_u32 v218, s64, v4
    v_xor_b32 v214, 0, v7
    v_xor_b32 v215, 32, v7
    v_xor_b32 v216, 64, v7
    v_xor_b32 v217, 96, v7
    s_waitcnt vmcnt(4)
    v_lshlrev_b32 v8, 16, v8
    v_lshlrev_b32 v9, 16, v9
    v_lshlrev_b32 v10, 16, v10
    v_mul_f32 v10, 0x3fb8aa3b, v10
    v_exp_f32 v10, v10
    s_nop 0
    v_cvt_pk_bf16_f32 v10, v10, v10
    v_lshlrev_b32 v10, 16, v10
    v_mul_f32 v8, v10, v8
    v_mul_f32 v9, v10, v9
    v_mul_f32 v8, 0x3fb8aa3b, v8
    v_mul_f32 v9, 0xbe22f983, v9
    v_mul_f32 v2, 0x43000000, v8
    v_mul_f32 v7, 0x43000000, v9
    v_exp_f32 v2, v2
    v_fract_f32 v7, v7
    v_cos_f32 v48, v7
    v_sin_f32 v49, v7
    v_mul_f32 v48, v48, v2
    v_mul_f32 v49, v49, v2
    v_exp_f32 v2, v8
    v_fract_f32 v7, v9
    v_cos_f32 v32, v7
    v_sin_f32 v40, v7
    v_mul_f32 v32, v32, v2
    v_mul_f32 v40, v40, v2
    s_add_u32 s64, s60, 16384
    s_add_u32 s65, s60, 81920
    buffer_load_dwordx4 v[80:83], v3, s[52:55], s64 offen
    buffer_load_dwordx4 v[84:87], v3, s[52:55], s65 offen
    v_mov_b32 v50, 0
    v_mov_b32 v51, 0
    v_mul_f32 v33, v32, v32
    v_mul_f32 v41, v32, v40
    v_fma_f32 v33, -v40, v40, v33
    v_add_f32 v41, v41, v41
    v_pk_mul_f32 v[34:35], v[32:33], v[32:33] op_sel:[0,1] op_sel_hi:[1,1]
    v_pk_mul_f32 v[42:43], v[32:33], v[40:41] op_sel:[0,1] op_sel_hi:[1,1]
    v_pk_fma_f32 v[34:35], v[40:41], v[40:41], v[34:35] op_sel:[0,1,0] op_sel_hi:[1,1,1] neg_lo:[1,0,0] neg_hi:[1,0,0]
    v_pk_fma_f32 v[42:43], v[40:41], v[32:33], v[42:43] op_sel:[0,1,0] op_sel_hi:[1,1,1]
    v_pk_mul_f32 v[36:37], v[32:33], v[34:35] op_sel:[0,1] op_sel_hi:[1,1]
    v_pk_mul_f32 v[44:45], v[32:33], v[42:43] op_sel:[0,1] op_sel_hi:[1,1]
    v_pk_fma_f32 v[36:37], v[40:41], v[42:43], v[36:37] op_sel:[0,1,0] op_sel_hi:[1,1,1] neg_lo:[1,0,0] neg_hi:[1,0,0]
    v_pk_fma_f32 v[44:45], v[40:41], v[34:35], v[44:45] op_sel:[0,1,0] op_sel_hi:[1,1,1]
    v_pk_mul_f32 v[38:39], v[34:35], v[34:35] op_sel:[0,1] op_sel_hi:[1,1]
    v_pk_mul_f32 v[46:47], v[34:35], v[42:43] op_sel:[0,1] op_sel_hi:[1,1]
    v_pk_fma_f32 v[38:39], v[42:43], v[42:43], v[38:39] op_sel:[0,1,0] op_sel_hi:[1,1,1] neg_lo:[1,0,0] neg_hi:[1,0,0]
    v_pk_fma_f32 v[46:47], v[42:43], v[34:35], v[46:47] op_sel:[0,1,0] op_sel_hi:[1,1,1]
    s_cmp_le_u32 s6, 0
    s_cbranch_scc1 L_Sdone_1003
    v_lshlrev_b32 v54, 16, v12
    v_and_b32 v55, 0xffff0000, v12
    v_pk_fma_f32 v[54:55], v[50:51], v[48:49], v[54:55] op_sel:[0,0,0] op_sel_hi:[1,0,1]
    v_pk_fma_f32 v[50:51], v[50:51], v[48:49], v[54:55] op_sel:[1,1,0] op_sel_hi:[0,1,1] neg_lo:[1,0,0]
    s_cmp_le_u32 s6, 1
    s_cbranch_scc1 L_Sdone_1003
    v_lshlrev_b32 v56, 16, v13
    v_and_b32 v57, 0xffff0000, v13
    v_pk_fma_f32 v[56:57], v[50:51], v[48:49], v[56:57] op_sel:[0,0,0] op_sel_hi:[1,0,1]
    v_pk_fma_f32 v[50:51], v[50:51], v[48:49], v[56:57] op_sel:[1,1,0] op_sel_hi:[0,1,1] neg_lo:[1,0,0]
    s_cmp_le_u32 s6, 2
    s_cbranch_scc1 L_Sdone_1003
    v_lshlrev_b32 v54, 16, v14
    v_and_b32 v55, 0xffff0000, v14
    v_pk_fma_f32 v[54:55], v[50:51], v[48:49], v[54:55] op_sel:[0,0,0] op_sel_hi:[1,0,1]
    v_pk_fma_f32 v[50:51], v[50:51], v[48:49], v[54:55] op_sel:[1,1,0] op_sel_hi:[0,1,1] neg_lo:[1,0,0]
    s_cmp_le_u32 s6, 3
    s_cbranch_scc1 L_Sdone_1003
    v_lshlrev_b32 v56, 16, v15
    v_and_b32 v57, 0xffff0000, v15
    v_pk_fma_f32 v[56:57], v[50:51], v[48:49], v[56:57] op_sel:[0,0,0] op_sel_hi:[1,0,1]
    v_pk_fma_f32 v[50:51], v[50:51], v[48:49], v[56:57] op_sel:[1,1,0] op_sel_hi:[0,1,1] neg_lo:[1,0,0]
    s_cmp_le_u32 s6, 4
    s_cbranch_scc1 L_Sdone_1003
    v_lshlrev_b32 v54, 16, v16
    v_and_b32 v55, 0xffff0000, v16
    v_pk_fma_f32 v[54:55], v[50:51], v[48:49], v[54:55] op_sel:[0,0,0] op_sel_hi:[1,0,1]
    v_pk_fma_f32 v[50:51], v[50:51], v[48:49], v[54:55] op_sel:[1,1,0] op_sel_hi:[0,1,1] neg_lo:[1,0,0]
    s_cmp_le_u32 s6, 5
    s_cbranch_scc1 L_Sdone_1003
    v_lshlrev_b32 v56, 16, v17
    v_and_b32 v57, 0xffff0000, v17
    v_pk_fma_f32 v[56:57], v[50:51], v[48:49], v[56:57] op_sel:[0,0,0] op_sel_hi:[1,0,1]
    v_pk_fma_f32 v[50:51], v[50:51], v[48:49], v[56:57] op_sel:[1,1,0] op_sel_hi:[0,1,1] neg_lo:[1,0,0]
    s_cmp_le_u32 s6, 6
    s_cbranch_scc1 L_Sdone_1003
    v_lshlrev_b32 v54, 16, v18
    v_and_b32 v55, 0xffff0000, v18
    v_pk_fma_f32 v[54:55], v[50:51], v[48:49], v[54:55] op_sel:[0,0,0] op_sel_hi:[1,0,1]
    v_pk_fma_f32 v[50:51], v[50:51], v[48:49], v[54:55] op_sel:[1,1,0] op_sel_hi:[0,1,1] neg_lo:[1,0,0]
    s_cmp_le_u32 s6, 7
    s_cbranch_scc1 L_Sdone_1003
    v_lshlrev_b32 v56, 16, v19
    v_and_b32 v57, 0xffff0000, v19
    v_pk_fma_f32 v[56:57], v[50:51], v[48:49], v[56:57] op_sel:[0,0,0] op_sel_hi:[1,0,1]
    v_pk_fma_f32 v[50:51], v[50:51], v[48:49], v[56:57] op_sel:[1,1,0] op_sel_hi:[0,1,1] neg_lo:[1,0,0]
    s_cmp_le_u32 s6, 8
    s_cbranch_scc1 L_Sdone_1003
    v_lshlrev_b32 v54, 16, v20
    v_and_b32 v55, 0xffff0000, v20
    v_pk_fma_f32 v[54:55], v[50:51], v[48:49], v[54:55] op_sel:[0,0,0] op_sel_hi:[1,0,1]
    v_pk_fma_f32 v[50:51], v[50:51], v[48:49], v[54:55] op_sel:[1,1,0] op_sel_hi:[0,1,1] neg_lo:[1,0,0]
    s_cmp_le_u32 s6, 9
    s_cbranch_scc1 L_Sdone_1003
    v_lshlrev_b32 v56, 16, v21
    v_and_b32 v57, 0xffff0000, v21
    v_pk_fma_f32 v[56:57], v[50:51], v[48:49], v[56:57] op_sel:[0,0,0] op_sel_hi:[1,0,1]
    v_pk_fma_f32 v[50:51], v[50:51], v[48:49], v[56:57] op_sel:[1,1,0] op_sel_hi:[0,1,1] neg_lo:[1,0,0]
    s_cmp_le_u32 s6, 10
    s_cbranch_scc1 L_Sdone_1003
    v_lshlrev_b32 v54, 16, v22
    v_and_b32 v55, 0xffff0000, v22
    v_pk_fma_f32 v[54:55], v[50:51], v[48:49], v[54:55] op_sel:[0,0,0] op_sel_hi:[1,0,1]
    v_pk_fma_f32 v[50:51], v[50:51], v[48:49], v[54:55] op_sel:[1,1,0] op_sel_hi:[0,1,1] neg_lo:[1,0,0]
    s_cmp_le_u32 s6, 11
    s_cbranch_scc1 L_Sdone_1003
    v_lshlrev_b32 v56, 16, v23
    v_and_b32 v57, 0xffff0000, v23
    v_pk_fma_f32 v[56:57], v[50:51], v[48:49], v[56:57] op_sel:[0,0,0] op_sel_hi:[1,0,1]
    v_pk_fma_f32 v[50:51], v[50:51], v[48:49], v[56:57] op_sel:[1,1,0] op_sel_hi:[0,1,1] neg_lo:[1,0,0]
    s_cmp_le_u32 s6, 12
    s_cbranch_scc1 L_Sdone_1003
    v_lshlrev_b32 v54, 16, v24
    v_and_b32 v55, 0xffff0000, v24
    v_pk_fma_f32 v[54:55], v[50:51], v[48:49], v[54:55] op_sel:[0,0,0] op_sel_hi:[1,0,1]
    v_pk_fma_f32 v[50:51], v[50:51], v[48:49], v[54:55] op_sel:[1,1,0] op_sel_hi:[0,1,1] neg_lo:[1,0,0]
    s_cmp_le_u32 s6, 13
    s_cbranch_scc1 L_Sdone_1003
    v_lshlrev_b32 v56, 16, v25
    v_and_b32 v57, 0xffff0000, v25
    v_pk_fma_f32 v[56:57], v[50:51], v[48:49], v[56:57] op_sel:[0,0,0] op_sel_hi:[1,0,1]
    v_pk_fma_f32 v[50:51], v[50:51], v[48:49], v[56:57] op_sel:[1,1,0] op_sel_hi:[0,1,1] neg_lo:[1,0,0]
    s_cmp_le_u32 s6, 14
    s_cbranch_scc1 L_Sdone_1003
    v_lshlrev_b32 v54, 16, v26
    v_and_b32 v55, 0xffff0000, v26
    v_pk_fma_f32 v[54:55], v[50:51], v[48:49], v[54:55] op_sel:[0,0,0] op_sel_hi:[1,0,1]
    v_pk_fma_f32 v[50:51], v[50:51], v[48:49], v[54:55] op_sel:[1,1,0] op_sel_hi:[0,1,1] neg_lo:[1,0,0]
L_Sdone_1003:
    s_add_u32 s64, s60, 24576
    s_add_u32 s65, s60, 90112
    buffer_load_dwordx4 v[88:91], v3, s[52:55], s64 offen
    buffer_load_dwordx4 v[92:95], v3, s[52:55], s65 offen
    s_bitcmp0_b32 s3, 0
    s_cbranch_scc1 L_even_1004
    v_mul_f32 v2, 0x42800000, v8
    v_mul_f32 v7, 0x42800000, v9
    v_exp_f32 v2, v2
    v_fract_f32 v7, v7
    v_cos_f32 v48, v7
    v_sin_f32 v49, v7
    v_mul_f32 v48, v48, v2
    v_mul_f32 v49, v49, v2
    v_pk_mul_f32 v[52:53], v[50:51], v[48:49] op_sel:[0,0] op_sel_hi:[1,0]
    v_pk_fma_f32 v[50:51], v[50:51], v[48:49], v[52:53] op_sel:[1,1,0] op_sel_hi:[0,1,1] neg_lo:[1,0,0]
L_even_1004:
    s_waitcnt vmcnt(6)
    s_add_u32 s64, s60, 32768
    s_add_u32 s65, s60, 98304
    buffer_load_dwordx4 v[96:99], v3, s[52:55], s64 offen
    buffer_load_dwordx4 v[100:103], v3, s[52:55], s65 offen
    v_lshlrev_b32 v54, 16, v64
    v_and_b32 v55, 0xffff0000, v64
    v_lshlrev_b32 v56, 16, v68
    v_and_b32 v57, 0xffff0000, v68
    v_fmac_f32 v54, v32, v50
    v_fmac_f32 v56, v32, v51
    v_fmac_f32 v55, v33, v50
    v_fmac_f32 v57, v33, v51
    v_mul_f32 v52, v50, v39
    v_mul_f32 v53, v51, v39
    v_fma_f32 v54, -v40, v51, v54
    v_fmac_f32 v56, v40, v50
    v_fma_f32 v55, -v41, v51, v55
    v_fmac_f32 v57, v41, v50
    v_cvt_pk_bf16_f32 v64, v54, v55
    v_cvt_pk_bf16_f32 v68, v56, v57
    v_lshlrev_b32 v58, 16, v65
    v_and_b32 v59, 0xffff0000, v65
    v_lshlrev_b32 v60, 16, v69
    v_and_b32 v61, 0xffff0000, v69
    v_fmac_f32 v58, v34, v50
    v_fmac_f32 v60, v34, v51
    v_fmac_f32 v59, v35, v50
    v_fmac_f32 v61, v35, v51
    v_fma_f32 v52, -v51, v47, v52
    v_fma_f32 v53, v50, v47, v53
    v_fma_f32 v58, -v42, v51, v58
    v_fmac_f32 v60, v42, v50
    v_fma_f32 v59, -v43, v51, v59
    v_fmac_f32 v61, v43, v50
    v_cvt_pk_bf16_f32 v65, v58, v59
    v_cvt_pk_bf16_f32 v69, v60, v61
    v_lshlrev_b32 v54, 16, v66
    v_and_b32 v55, 0xffff0000, v66
    v_lshlrev_b32 v56, 16, v70
    v_and_b32 v57, 0xffff0000, v70
    v_xor_b32 v2, 0, v28
    v_fmac_f32 v54, v36, v50
    v_fmac_f32 v56, v36, v51
    v_fmac_f32 v55, v37, v50
    v_fmac_f32 v57, v37, v51
    v_fma_f32 v54, -v44, v51, v54
    v_fmac_f32 v56, v44, v50
    v_fma_f32 v55, -v45, v51, v55
    v_fmac_f32 v57, v45, v50
    v_cvt_pk_bf16_f32 v66, v54, v55
    v_cvt_pk_bf16_f32 v70, v56, v57
    v_lshlrev_b32 v58, 16, v67
    v_and_b32 v59, 0xffff0000, v67
    v_lshlrev_b32 v60, 16, v71
    v_and_b32 v61, 0xffff0000, v71
    v_fmac_f32 v58, v38, v50
    v_fmac_f32 v60, v38, v51
    v_fmac_f32 v59, v39, v50
    v_fmac_f32 v61, v39, v51
    v_fma_f32 v58, -v46, v51, v58
    v_fmac_f32 v60, v46, v50
    v_fma_f32 v59, -v47, v51, v59
    v_fmac_f32 v61, v47, v50
    v_cvt_pk_bf16_f32 v67, v58, v59
    v_cvt_pk_bf16_f32 v71, v60, v61
    ds_write_b128 v2, v[64:67]
    ds_write_b128 v2, v[68:71] offset:32768
    s_waitcnt vmcnt(6)
    s_add_u32 s64, s60, 40960
    s_add_u32 s65, s60, 106496
    buffer_load_dwordx4 v[104:107], v3, s[52:55], s64 offen
    buffer_load_dwordx4 v[108:111], v3, s[52:55], s65 offen
    v_lshlrev_b32 v54, 16, v72
    v_and_b32 v55, 0xffff0000, v72
    v_lshlrev_b32 v56, 16, v76
    v_and_b32 v57, 0xffff0000, v76
    v_fmac_f32 v54, v32, v52
    v_fmac_f32 v56, v32, v53
    v_fmac_f32 v55, v33, v52
    v_fmac_f32 v57, v33, v53
    v_mul_f32 v50, v52, v39
    v_mul_f32 v51, v53, v39
    v_fma_f32 v54, -v40, v53, v54
    v_fmac_f32 v56, v40, v52
    v_fma_f32 v55, -v41, v53, v55
    v_fmac_f32 v57, v41, v52
    v_cvt_pk_bf16_f32 v72, v54, v55
    v_cvt_pk_bf16_f32 v76, v56, v57
    v_lshlrev_b32 v58, 16, v73
    v_and_b32 v59, 0xffff0000, v73
    v_lshlrev_b32 v60, 16, v77
    v_and_b32 v61, 0xffff0000, v77
    v_fmac_f32 v58, v34, v52
    v_fmac_f32 v60, v34, v53
    v_fmac_f32 v59, v35, v52
    v_fmac_f32 v61, v35, v53
    v_fma_f32 v50, -v53, v47, v50
    v_fma_f32 v51, v52, v47, v51
    v_fma_f32 v58, -v42, v53, v58
    v_fmac_f32 v60, v42, v52
    v_fma_f32 v59, -v43, v53, v59
    v_fmac_f32 v61, v43, v52
    v_cvt_pk_bf16_f32 v73, v58, v59
    v_cvt_pk_bf16_f32 v77, v60, v61
    v_lshlrev_b32 v54, 16, v74
    v_and_b32 v55, 0xffff0000, v74
    v_lshlrev_b32 v56, 16, v78
    v_and_b32 v57, 0xffff0000, v78
    v_xor_b32 v2, 16, v28
    v_fmac_f32 v54, v36, v52
    v_fmac_f32 v56, v36, v53
    v_fmac_f32 v55, v37, v52
    v_fmac_f32 v57, v37, v53
    v_fma_f32 v54, -v44, v53, v54
    v_fmac_f32 v56, v44, v52
    v_fma_f32 v55, -v45, v53, v55
    v_fmac_f32 v57, v45, v52
    v_cvt_pk_bf16_f32 v74, v54, v55
    v_cvt_pk_bf16_f32 v78, v56, v57
    v_lshlrev_b32 v58, 16, v75
    v_and_b32 v59, 0xffff0000, v75
    v_lshlrev_b32 v60, 16, v79
    v_and_b32 v61, 0xffff0000, v79
    v_fmac_f32 v58, v38, v52
    v_fmac_f32 v60, v38, v53
    v_fmac_f32 v59, v39, v52
    v_fmac_f32 v61, v39, v53
    v_fma_f32 v58, -v46, v53, v58
    v_fmac_f32 v60, v46, v52
    v_fma_f32 v59, -v47, v53, v59
    v_fmac_f32 v61, v47, v52
    v_cvt_pk_bf16_f32 v75, v58, v59
    v_cvt_pk_bf16_f32 v79, v60, v61
    ds_write_b128 v2, v[72:75]
    ds_write_b128 v2, v[76:79] offset:32768
    s_waitcnt vmcnt(6)
    s_add_u32 s64, s60, 49152
    s_add_u32 s65, s60, 114688
    buffer_load_dwordx4 v[112:115], v3, s[52:55], s64 offen
    buffer_load_dwordx4 v[116:119], v3, s[52:55], s65 offen
    v_lshlrev_b32 v54, 16, v80
    v_and_b32 v55, 0xffff0000, v80
    v_lshlrev_b32 v56, 16, v84
    v_and_b32 v57, 0xffff0000, v84
    v_fmac_f32 v54, v32, v50
    v_fmac_f32 v56, v32, v51
    v_fmac_f32 v55, v33, v50
    v_fmac_f32 v57, v33, v51
    v_mul_f32 v52, v50, v39
    v_mul_f32 v53, v51, v39
    v_fma_f32 v54, -v40, v51, v54
    v_fmac_f32 v56, v40, v50
    v_fma_f32 v55, -v41, v51, v55
    v_fmac_f32 v57, v41, v50
    v_cvt_pk_bf16_f32 v80, v54, v55
    v_cvt_pk_bf16_f32 v84, v56, v57
    v_lshlrev_b32 v58, 16, v81
    v_and_b32 v59, 0xffff0000, v81
    v_lshlrev_b32 v60, 16, v85
    v_and_b32 v61, 0xffff0000, v85
    v_fmac_f32 v58, v34, v50
    v_fmac_f32 v60, v34, v51
    v_fmac_f32 v59, v35, v50
    v_fmac_f32 v61, v35, v51
    v_fma_f32 v52, -v51, v47, v52
    v_fma_f32 v53, v50, v47, v53
    v_fma_f32 v58, -v42, v51, v58
    v_fmac_f32 v60, v42, v50
    v_fma_f32 v59, -v43, v51, v59
    v_fmac_f32 v61, v43, v50
    v_cvt_pk_bf16_f32 v81, v58, v59
    v_cvt_pk_bf16_f32 v85, v60, v61
    v_lshlrev_b32 v54, 16, v82
    v_and_b32 v55, 0xffff0000, v82
    v_lshlrev_b32 v56, 16, v86
    v_and_b32 v57, 0xffff0000, v86
    v_xor_b32 v2, 32, v28
    v_fmac_f32 v54, v36, v50
    v_fmac_f32 v56, v36, v51
    v_fmac_f32 v55, v37, v50
    v_fmac_f32 v57, v37, v51
    v_fma_f32 v54, -v44, v51, v54
    v_fmac_f32 v56, v44, v50
    v_fma_f32 v55, -v45, v51, v55
    v_fmac_f32 v57, v45, v50
    v_cvt_pk_bf16_f32 v82, v54, v55
    v_cvt_pk_bf16_f32 v86, v56, v57
    v_lshlrev_b32 v58, 16, v83
    v_and_b32 v59, 0xffff0000, v83
    v_lshlrev_b32 v60, 16, v87
    v_and_b32 v61, 0xffff0000, v87
    v_fmac_f32 v58, v38, v50
    v_fmac_f32 v60, v38, v51
    v_fmac_f32 v59, v39, v50
    v_fmac_f32 v61, v39, v51
    v_fma_f32 v58, -v46, v51, v58
    v_fmac_f32 v60, v46, v50
    v_fma_f32 v59, -v47, v51, v59
    v_fmac_f32 v61, v47, v50
    v_cvt_pk_bf16_f32 v83, v58, v59
    v_cvt_pk_bf16_f32 v87, v60, v61
    ds_write_b128 v2, v[80:83]
    ds_write_b128 v2, v[84:87] offset:32768
    s_cmp_lg_u32 s61, 1
    s_cbranch_scc1 L_gb_1005
    s_barrier
L_gb_1005:
    s_waitcnt vmcnt(6)
    s_add_u32 s64, s60, 57344
    s_add_u32 s65, s60, 122880
    buffer_load_dwordx4 v[120:123], v3, s[52:55], s64 offen
    buffer_load_dwordx4 v[124:127], v3, s[52:55], s65 offen
    v_lshlrev_b32 v54, 16, v88
    v_and_b32 v55, 0xffff0000, v88
    v_lshlrev_b32 v56, 16, v92
    v_and_b32 v57, 0xffff0000, v92
    v_fmac_f32 v54, v32, v52
    v_fmac_f32 v56, v32, v53
    v_fmac_f32 v55, v33, v52
    v_fmac_f32 v57, v33, v53
    v_mul_f32 v50, v52, v39
    v_mul_f32 v51, v53, v39
    v_fma_f32 v54, -v40, v53, v54
    v_fmac_f32 v56, v40, v52
    v_fma_f32 v55, -v41, v53, v55
    v_fmac_f32 v57, v41, v52
    v_cvt_pk_bf16_f32 v88, v54, v55
    v_cvt_pk_bf16_f32 v92, v56, v57
    v_lshlrev_b32 v58, 16, v89
    v_and_b32 v59, 0xffff0000, v89
    v_lshlrev_b32 v60, 16, v93
    v_and_b32 v61, 0xffff0000, v93
    v_fmac_f32 v58, v34, v52
    v_fmac_f32 v60, v34, v53
    v_fmac_f32 v59, v35, v52
    v_fmac_f32 v61, v35, v53
    v_fma_f32 v50, -v53, v47, v50
    v_fma_f32 v51, v52, v47, v51
    v_fma_f32 v58, -v42, v53, v58
    v_fmac_f32 v60, v42, v52
    v_fma_f32 v59, -v43, v53, v59
    v_fmac_f32 v61, v43, v52
    v_cvt_pk_bf16_f32 v89, v58, v59
    v_cvt_pk_bf16_f32 v93, v60, v61
    v_lshlrev_b32 v54, 16, v90
    v_and_b32 v55, 0xffff0000, v90
    v_lshlrev_b32 v56, 16, v94
    v_and_b32 v57, 0xffff0000, v94
    v_xor_b32 v2, 48, v28
    v_fmac_f32 v54, v36, v52
    v_fmac_f32 v56, v36, v53
    v_fmac_f32 v55, v37, v52
    v_fmac_f32 v57, v37, v53
    v_fma_f32 v54, -v44, v53, v54
    v_fmac_f32 v56, v44, v52
    v_fma_f32 v55, -v45, v53, v55
    v_fmac_f32 v57, v45, v52
    v_cvt_pk_bf16_f32 v90, v54, v55
    v_cvt_pk_bf16_f32 v94, v56, v57
    v_lshlrev_b32 v58, 16, v91
    v_and_b32 v59, 0xffff0000, v91
    v_lshlrev_b32 v60, 16, v95
    v_and_b32 v61, 0xffff0000, v95
    v_fmac_f32 v58, v38, v52
    v_fmac_f32 v60, v38, v53
    v_fmac_f32 v59, v39, v52
    v_fmac_f32 v61, v39, v53
    v_fma_f32 v58, -v46, v53, v58
    v_fmac_f32 v60, v46, v52
    v_fma_f32 v59, -v47, v53, v59
    v_fmac_f32 v61, v47, v52
    v_cvt_pk_bf16_f32 v91, v58, v59
    v_cvt_pk_bf16_f32 v95, v60, v61
    ds_write_b128 v2, v[88:91]
    ds_write_b128 v2, v[92:95] offset:32768
    s_waitcnt vmcnt(6)
    buffer_load_dwordx4 v[128:131], v4, s[52:55], s63 offen offset:0
    buffer_load_dwordx4 v[132:135], v4, s[52:55], s72 offen offset:0
    v_lshlrev_b32 v54, 16, v96
    v_and_b32 v55, 0xffff0000, v96
    v_lshlrev_b32 v56, 16, v100
    v_and_b32 v57, 0xffff0000, v100
    v_fmac_f32 v54, v32, v50
    v_fmac_f32 v56, v32, v51
    v_fmac_f32 v55, v33, v50
    v_fmac_f32 v57, v33, v51
    v_mul_f32 v52, v50, v39
    v_mul_f32 v53, v51, v39
    v_fma_f32 v54, -v40, v51, v54
    v_fmac_f32 v56, v40, v50
    v_fma_f32 v55, -v41, v51, v55
    v_fmac_f32 v57, v41, v50
    v_cvt_pk_bf16_f32 v96, v54, v55
    v_cvt_pk_bf16_f32 v100, v56, v57
    v_lshlrev_b32 v58, 16, v97
    v_and_b32 v59, 0xffff0000, v97
    v_lshlrev_b32 v60, 16, v101
    v_and_b32 v61, 0xffff0000, v101
    v_fmac_f32 v58, v34, v50
    v_fmac_f32 v60, v34, v51
    v_fmac_f32 v59, v35, v50
    v_fmac_f32 v61, v35, v51
    v_fma_f32 v52, -v51, v47, v52
    v_fma_f32 v53, v50, v47, v53
    v_fma_f32 v58, -v42, v51, v58
    v_fmac_f32 v60, v42, v50
    v_fma_f32 v59, -v43, v51, v59
    v_fmac_f32 v61, v43, v50
    v_cvt_pk_bf16_f32 v97, v58, v59
    v_cvt_pk_bf16_f32 v101, v60, v61
    v_lshlrev_b32 v54, 16, v98
    v_and_b32 v55, 0xffff0000, v98
    v_lshlrev_b32 v56, 16, v102
    v_and_b32 v57, 0xffff0000, v102
    v_xor_b32 v2, 64, v28
    v_fmac_f32 v54, v36, v50
    v_fmac_f32 v56, v36, v51
    v_fmac_f32 v55, v37, v50
    v_fmac_f32 v57, v37, v51
    v_fma_f32 v54, -v44, v51, v54
    v_fmac_f32 v56, v44, v50
    v_fma_f32 v55, -v45, v51, v55
    v_fmac_f32 v57, v45, v50
    v_cvt_pk_bf16_f32 v98, v54, v55
    v_cvt_pk_bf16_f32 v102, v56, v57
    v_lshlrev_b32 v58, 16, v99
    v_and_b32 v59, 0xffff0000, v99
    v_lshlrev_b32 v60, 16, v103
    v_and_b32 v61, 0xffff0000, v103
    v_fmac_f32 v58, v38, v50
    v_fmac_f32 v60, v38, v51
    v_fmac_f32 v59, v39, v50
    v_fmac_f32 v61, v39, v51
    v_fma_f32 v58, -v46, v51, v58
    v_fmac_f32 v60, v46, v50
    v_fma_f32 v59, -v47, v51, v59
    v_fmac_f32 v61, v47, v50
    v_cvt_pk_bf16_f32 v99, v58, v59
    v_cvt_pk_bf16_f32 v103, v60, v61
    ds_write_b128 v2, v[96:99]
    ds_write_b128 v2, v[100:103] offset:32768
    s_waitcnt vmcnt(6)
    buffer_load_dwordx4 v[136:139], v4, s[52:55], s63 offen offset:1024
    buffer_load_dwordx4 v[140:143], v4, s[52:55], s72 offen offset:1024
    v_lshlrev_b32 v54, 16, v104
    v_and_b32 v55, 0xffff0000, v104
    v_lshlrev_b32 v56, 16, v108
    v_and_b32 v57, 0xffff0000, v108
    v_fmac_f32 v54, v32, v52
    v_fmac_f32 v56, v32, v53
    v_fmac_f32 v55, v33, v52
    v_fmac_f32 v57, v33, v53
    v_mul_f32 v50, v52, v39
    v_mul_f32 v51, v53, v39
    v_fma_f32 v54, -v40, v53, v54
    v_fmac_f32 v56, v40, v52
    v_fma_f32 v55, -v41, v53, v55
    v_fmac_f32 v57, v41, v52
    v_cvt_pk_bf16_f32 v104, v54, v55
    v_cvt_pk_bf16_f32 v108, v56, v57
    v_lshlrev_b32 v58, 16, v105
    v_and_b32 v59, 0xffff0000, v105
    v_lshlrev_b32 v60, 16, v109
    v_and_b32 v61, 0xffff0000, v109
    v_fmac_f32 v58, v34, v52
    v_fmac_f32 v60, v34, v53
    v_fmac_f32 v59, v35, v52
    v_fmac_f32 v61, v35, v53
    v_fma_f32 v50, -v53, v47, v50
    v_fma_f32 v51, v52, v47, v51
    v_fma_f32 v58, -v42, v53, v58
    v_fmac_f32 v60, v42, v52
    v_fma_f32 v59, -v43, v53, v59
    v_fmac_f32 v61, v43, v52
    v_cvt_pk_bf16_f32 v105, v58, v59
    v_cvt_pk_bf16_f32 v109, v60, v61
    v_lshlrev_b32 v54, 16, v106
    v_and_b32 v55, 0xffff0000, v106
    v_lshlrev_b32 v56, 16, v110
    v_and_b32 v57, 0xffff0000, v110
    v_xor_b32 v2, 80, v28
    v_fmac_f32 v54, v36, v52
    v_fmac_f32 v56, v36, v53
    v_fmac_f32 v55, v37, v52
    v_fmac_f32 v57, v37, v53
    v_fma_f32 v54, -v44, v53, v54
    v_fmac_f32 v56, v44, v52
    v_fma_f32 v55, -v45, v53, v55
    v_fmac_f32 v57, v45, v52
    v_cvt_pk_bf16_f32 v106, v54, v55
    v_cvt_pk_bf16_f32 v110, v56, v57
    v_lshlrev_b32 v58, 16, v107
    v_and_b32 v59, 0xffff0000, v107
    v_lshlrev_b32 v60, 16, v111
    v_and_b32 v61, 0xffff0000, v111
    v_fmac_f32 v58, v38, v52
    v_fmac_f32 v60, v38, v53
    v_fmac_f32 v59, v39, v52
    v_fmac_f32 v61, v39, v53
    v_fma_f32 v58, -v46, v53, v58
    v_fmac_f32 v60, v46, v52
    v_fma_f32 v59, -v47, v53, v59
    v_fmac_f32 v61, v47, v52
    v_cvt_pk_bf16_f32 v107, v58, v59
    v_cvt_pk_bf16_f32 v111, v60, v61
    ds_write_b128 v2, v[104:107]
    ds_write_b128 v2, v[108:111] offset:32768
    s_waitcnt vmcnt(6)
    buffer_load_dwordx4 v[144:147], v4, s[52:55], s63 offen offset:2048
    buffer_load_dwordx4 v[148:151], v4, s[52:55], s72 offen offset:2048
    buffer_load_dwordx4 v[152:155], v4, s[52:55], s63 offen offset:3072
    v_lshlrev_b32 v54, 16, v112
    v_and_b32 v55, 0xffff0000, v112
    v_lshlrev_b32 v56, 16, v116
    v_and_b32 v57, 0xffff0000, v116
    v_fmac_f32 v54, v32, v50
    v_fmac_f32 v56, v32, v51
    v_fmac_f32 v55, v33, v50
    v_fmac_f32 v57, v33, v51
    v_mul_f32 v52, v50, v39
    v_mul_f32 v53, v51, v39
    v_fma_f32 v54, -v40, v51, v54
    v_fmac_f32 v56, v40, v50
    v_fma_f32 v55, -v41, v51, v55
    v_fmac_f32 v57, v41, v50
    v_cvt_pk_bf16_f32 v112, v54, v55
    v_cvt_pk_bf16_f32 v116, v56, v57
    v_lshlrev_b32 v58, 16, v113
    v_and_b32 v59, 0xffff0000, v113
    v_lshlrev_b32 v60, 16, v117
    v_and_b32 v61, 0xffff0000, v117
    v_fmac_f32 v58, v34, v50
    v_fmac_f32 v60, v34, v51
    v_fmac_f32 v59, v35, v50
    v_fmac_f32 v61, v35, v51
    v_fma_f32 v52, -v51, v47, v52
    v_fma_f32 v53, v50, v47, v53
    v_fma_f32 v58, -v42, v51, v58
    v_fmac_f32 v60, v42, v50
    v_fma_f32 v59, -v43, v51, v59
    v_fmac_f32 v61, v43, v50
    v_cvt_pk_bf16_f32 v113, v58, v59
    v_cvt_pk_bf16_f32 v117, v60, v61
    v_lshlrev_b32 v54, 16, v114
    v_and_b32 v55, 0xffff0000, v114
    v_lshlrev_b32 v56, 16, v118
    v_and_b32 v57, 0xffff0000, v118
    v_xor_b32 v2, 96, v28
    v_fmac_f32 v54, v36, v50
    v_fmac_f32 v56, v36, v51
    v_fmac_f32 v55, v37, v50
    v_fmac_f32 v57, v37, v51
    v_fma_f32 v54, -v44, v51, v54
    v_fmac_f32 v56, v44, v50
    v_fma_f32 v55, -v45, v51, v55
    v_fmac_f32 v57, v45, v50
    v_cvt_pk_bf16_f32 v114, v54, v55
    v_cvt_pk_bf16_f32 v118, v56, v57
    v_lshlrev_b32 v58, 16, v115
    v_and_b32 v59, 0xffff0000, v115
    v_lshlrev_b32 v60, 16, v119
    v_and_b32 v61, 0xffff0000, v119
    v_fmac_f32 v58, v38, v50
    v_fmac_f32 v60, v38, v51
    v_fmac_f32 v59, v39, v50
    v_fmac_f32 v61, v39, v51
    v_fma_f32 v58, -v46, v51, v58
    v_fmac_f32 v60, v46, v50
    v_fma_f32 v59, -v47, v51, v59
    v_fmac_f32 v61, v47, v50
    v_cvt_pk_bf16_f32 v115, v58, v59
    v_cvt_pk_bf16_f32 v119, v60, v61
    ds_write_b128 v2, v[112:115]
    ds_write_b128 v2, v[116:119] offset:32768
    s_waitcnt vmcnt(7)
    buffer_load_dwordx4 v[156:159], v4, s[52:55], s72 offen offset:3072
    s_cmp_lg_u32 s61, 0
    s_cbranch_scc1 L_eB_1006
    global_load_dwordx4 v[192:195], v220, s[8:9]
    global_load_dwordx4 v[196:199], v221, s[8:9]
    global_load_short_d16_hi v204, v224, s[24:25]
    global_load_short_d16_hi v205, v224, s[24:25] offset:32
    s_branch L_eJ_1007
L_eB_1006:
    s_add_u32 s68, s73, 0x10000
    buffer_load_dwordx4 v[192:195], v222, s[52:55], s73 offen
    buffer_load_dwordx4 v[196:199], v222, s[52:55], s68 offen
    buffer_load_dword v204, v223, s[52:55], s74 offen
    buffer_load_dword v205, v223, s[52:55], s74 offen offset:64
L_eJ_1007:
    s_add_u32 s63, s63, 4096
    buffer_load_dwordx4 v[160:163], v4, s[52:55], s63 offen offset:0
    v_lshlrev_b32 v54, 16, v120
    v_and_b32 v55, 0xffff0000, v120
    v_lshlrev_b32 v56, 16, v124
    v_and_b32 v57, 0xffff0000, v124
    v_fmac_f32 v54, v32, v52
    v_fmac_f32 v56, v32, v53
    v_fmac_f32 v55, v33, v52
    v_fmac_f32 v57, v33, v53
    v_fma_f32 v54, -v40, v53, v54
    v_fmac_f32 v56, v40, v52
    v_fma_f32 v55, -v41, v53, v55
    v_fmac_f32 v57, v41, v52
    v_cvt_pk_bf16_f32 v120, v54, v55
    v_cvt_pk_bf16_f32 v124, v56, v57
    v_lshlrev_b32 v58, 16, v121
    v_and_b32 v59, 0xffff0000, v121
    v_lshlrev_b32 v60, 16, v125
    v_and_b32 v61, 0xffff0000, v125
    v_fmac_f32 v58, v34, v52
    v_fmac_f32 v60, v34, v53
    v_fmac_f32 v59, v35, v52
    v_fmac_f32 v61, v35, v53
    v_fma_f32 v58, -v42, v53, v58
    v_fmac_f32 v60, v42, v52
    v_fma_f32 v59, -v43, v53, v59
    v_fmac_f32 v61, v43, v52
    v_cvt_pk_bf16_f32 v121, v58, v59
    v_cvt_pk_bf16_f32 v125, v60, v61
    v_lshlrev_b32 v54, 16, v122
    v_and_b32 v55, 0xffff0000, v122
    v_lshlrev_b32 v56, 16, v126
    v_and_b32 v57, 0xffff0000, v126
    v_xor_b32 v2, 112, v28
    v_fmac_f32 v54, v36, v52
    v_fmac_f32 v56, v36, v53
    v_fmac_f32 v55, v37, v52
    v_fmac_f32 v57, v37, v53
    v_fma_f32 v54, -v44, v53, v54
    v_fmac_f32 v56, v44, v52
    v_fma_f32 v55, -v45, v53, v55
    v_fmac_f32 v57, v45, v52
    v_cvt_pk_bf16_f32 v122, v54, v55
    v_cvt_pk_bf16_f32 v126, v56, v57
    v_lshlrev_b32 v58, 16, v123
    v_and_b32 v59, 0xffff0000, v123
    v_lshlrev_b32 v60, 16, v127
    v_and_b32 v61, 0xffff0000, v127
    v_fmac_f32 v58, v38, v52
    v_fmac_f32 v60, v38, v53
    v_fmac_f32 v59, v39, v52
    v_fmac_f32 v61, v39, v53
    v_fma_f32 v58, -v46, v53, v58
    v_fmac_f32 v60, v46, v52
    v_fma_f32 v59, -v47, v53, v59
    v_fmac_f32 v61, v47, v52
    v_cvt_pk_bf16_f32 v123, v58, v59
    v_cvt_pk_bf16_f32 v127, v60, v61
    ds_write_b128 v2, v[120:123]
    ds_write_b128 v2, v[124:127] offset:32768
    s_add_u32 s72, s72, 4096
    buffer_load_dwordx4 v[164:167], v4, s[52:55], s72 offen offset:0
    buffer_load_dwordx4 v[168:171], v4, s[52:55], s63 offen offset:1024
    buffer_load_dwordx4 v[172:175], v4, s[52:55], s72 offen offset:1024
    s_cmp_lg_u32 s61, 0
    s_cbranch_scc1 L_mB_1008
    v_mov_b32 v32, 0
    v_mov_b32 v33, 0
    v_mov_b32 v34, 0
    v_mov_b32 v35, 0
    v_mov_b32 v36, 0
    v_mov_b32 v37, 0
    v_mov_b32 v38, 0
    v_mov_b32 v39, 0
    v_mov_b32 v40, 0
    v_mov_b32 v41, 0
    v_mov_b32 v42, 0
    v_mov_b32 v43, 0
    v_mov_b32 v44, 0
    v_mov_b32 v45, 0
    v_mov_b32 v46, 0
    v_mov_b32 v47, 0
    v_mov_b32 v48, 0
    v_mov_b32 v49, 0
    v_mov_b32 v50, 0
    v_mov_b32 v51, 0
    v_mov_b32 v52, 0
    v_mov_b32 v53, 0
    v_mov_b32 v54, 0
    v_mov_b32 v55, 0
    v_mov_b32 v56, 0
    v_mov_b32 v57, 0
    v_mov_b32 v58, 0
    v_mov_b32 v59, 0
    v_mov_b32 v60, 0
    v_mov_b32 v61, 0
    v_mov_b32 v62, 0
    v_mov_b32 v63, 0
    s_waitcnt lgkmcnt(0)
    s_barrier
    s_branch L_mJ_1009
L_mB_1008:
    s_waitcnt lgkmcnt(0)
    s_barrier
    ds_read_b128 v[32:35], v218 offset:0
    ds_read_b128 v[36:39], v218 offset:1024
    ds_read_b128 v[40:43], v218 offset:2048
    ds_read_b128 v[44:47], v218 offset:3072
    ds_read_b128 v[48:51], v218 offset:4096
    ds_read_b128 v[52:55], v218 offset:5120
    ds_read_b128 v[56:59], v218 offset:6144
    ds_read_b128 v[60:63], v218 offset:7168
L_mJ_1009:
    ds_read_b64_tr_b16 v[72:73], v216 offset:0
    ds_read_b64_tr_b16 v[74:75], v216 offset:2048
    ds_read_b64_tr_b16 v[76:77], v217 offset:0
    ds_read_b64_tr_b16 v[78:79], v217 offset:2048
    s_waitcnt lgkmcnt(8)
    ds_read_b64_tr_b16 v[64:65], v214 offset:0
    ds_read_b64_tr_b16 v[66:67], v214 offset:2048
    ds_read_b64_tr_b16 v[68:69], v215 offset:0
    ds_read_b64_tr_b16 v[70:71], v215 offset:2048
    buffer_load_dwordx4 v[176:179], v4, s[52:55], s63 offen offset:2048
    buffer_load_dwordx4 v[180:183], v4, s[52:55], s72 offen offset:2048
    s_waitcnt vmcnt(16)
    ds_read_b64_tr_b16 v[88:89], v216 offset:4096
    ds_read_b64_tr_b16 v[90:91], v216 offset:6144
    s_waitcnt lgkmcnt(8)
    v_mfma_f32_16x16x32_bf16 v[40:43], v[128:131], v[72:75], v[40:43]
    v_mfma_f32_16x16x32_bf16 v[56:59], v[132:135], v[72:75], v[56:59]
    ds_read_b64_tr_b16 v[92:93], v217 offset:4096
    ds_read_b64_tr_b16 v[94:95], v217 offset:6144
    s_waitcnt lgkmcnt(8)
    v_mfma_f32_16x16x32_bf16 v[44:47], v[128:131], v[76:79], v[44:47]
    v_mfma_f32_16x16x32_bf16 v[60:63], v[132:135], v[76:79], v[60:63]
    ds_read_b64_tr_b16 v[80:81], v214 offset:4096
    ds_read_b64_tr_b16 v[82:83], v214 offset:6144
    s_waitcnt lgkmcnt(8)
    v_mfma_f32_16x16x32_bf16 v[32:35], v[128:131], v[64:67], v[32:35]
    v_mfma_f32_16x16x32_bf16 v[48:51], v[132:135], v[64:67], v[48:51]
    ds_read_b64_tr_b16 v[84:85], v215 offset:4096
    ds_read_b64_tr_b16 v[86:87], v215 offset:6144
    s_waitcnt lgkmcnt(8)
    v_mfma_f32_16x16x32_bf16 v[36:39], v[128:131], v[68:71], v[36:39]
    v_mfma_f32_16x16x32_bf16 v[52:55], v[132:135], v[68:71], v[52:55]
    buffer_load_dwordx4 v[184:187], v4, s[52:55], s63 offen offset:3072
    buffer_load_dwordx4 v[188:191], v4, s[52:55], s72 offen offset:3072
    s_waitcnt vmcnt(16)
    ds_read_b64_tr_b16 v[72:73], v216 offset:8192
    ds_read_b64_tr_b16 v[74:75], v216 offset:10240
    s_waitcnt lgkmcnt(8)
    v_mfma_f32_16x16x32_bf16 v[40:43], v[136:139], v[88:91], v[40:43]
    v_mfma_f32_16x16x32_bf16 v[56:59], v[140:143], v[88:91], v[56:59]
    ds_read_b64_tr_b16 v[76:77], v217 offset:8192
    ds_read_b64_tr_b16 v[78:79], v217 offset:10240
    s_waitcnt lgkmcnt(8)
    v_mfma_f32_16x16x32_bf16 v[44:47], v[136:139], v[92:95], v[44:47]
    v_mfma_f32_16x16x32_bf16 v[60:63], v[140:143], v[92:95], v[60:63]
    ds_read_b64_tr_b16 v[64:65], v214 offset:8192
    ds_read_b64_tr_b16 v[66:67], v214 offset:10240
    s_waitcnt lgkmcnt(8)
    v_mfma_f32_16x16x32_bf16 v[32:35], v[136:139], v[80:83], v[32:35]
    v_mfma_f32_16x16x32_bf16 v[48:51], v[140:143], v[80:83], v[48:51]
    ds_read_b64_tr_b16 v[68:69], v215 offset:8192
    ds_read_b64_tr_b16 v[70:71], v215 offset:10240
    s_waitcnt lgkmcnt(8)
    v_mfma_f32_16x16x32_bf16 v[36:39], v[136:139], v[84:87], v[36:39]
    v_mfma_f32_16x16x32_bf16 v[52:55], v[140:143], v[84:87], v[52:55]
    s_waitcnt vmcnt(14)
    ds_read_b64_tr_b16 v[88:89], v216 offset:12288
    ds_read_b64_tr_b16 v[90:91], v216 offset:14336
    s_waitcnt lgkmcnt(8)
    v_mfma_f32_16x16x32_bf16 v[40:43], v[144:147], v[72:75], v[40:43]
    v_mfma_f32_16x16x32_bf16 v[56:59], v[148:151], v[72:75], v[56:59]
    ds_read_b64_tr_b16 v[92:93], v217 offset:12288
    ds_read_b64_tr_b16 v[94:95], v217 offset:14336
    s_waitcnt lgkmcnt(8)
    v_mfma_f32_16x16x32_bf16 v[44:47], v[144:147], v[76:79], v[44:47]
    v_mfma_f32_16x16x32_bf16 v[60:63], v[148:151], v[76:79], v[60:63]
    ds_read_b64_tr_b16 v[80:81], v214 offset:12288
    ds_read_b64_tr_b16 v[82:83], v214 offset:14336
    s_waitcnt lgkmcnt(8)
    v_mfma_f32_16x16x32_bf16 v[32:35], v[144:147], v[64:67], v[32:35]
    v_mfma_f32_16x16x32_bf16 v[48:51], v[148:151], v[64:67], v[48:51]
    ds_read_b64_tr_b16 v[84:85], v215 offset:12288
    ds_read_b64_tr_b16 v[86:87], v215 offset:14336
    s_waitcnt lgkmcnt(8)
    v_mfma_f32_16x16x32_bf16 v[36:39], v[144:147], v[68:71], v[36:39]
    v_mfma_f32_16x16x32_bf16 v[52:55], v[148:151], v[68:71], v[52:55]
    s_waitcnt vmcnt(12)
    s_waitcnt vmcnt(8)
    ds_read_b64_tr_b16 v[72:73], v216 offset:16384
    ds_read_b64_tr_b16 v[74:75], v216 offset:18432
    s_waitcnt lgkmcnt(8)
    v_mfma_f32_16x16x32_bf16 v[40:43], v[152:155], v[88:91], v[40:43]
    v_lshrrev_b32 v2, 1, v5
    v_mfma_f32_16x16x32_bf16 v[56:59], v[156:159], v[88:91], v[56:59]
    v_lshlrev_b32 v7, 2, v6
    v_sub_u32 v2, v2, v7
    ds_read_b64_tr_b16 v[76:77], v217 offset:16384
    ds_read_b64_tr_b16 v[78:79], v217 offset:18432
    s_waitcnt lgkmcnt(8)
    v_mfma_f32_16x16x32_bf16 v[44:47], v[152:155], v[92:95], v[44:47]
    v_and_b32 v11, 1, v5
    v_mfma_f32_16x16x32_bf16 v[60:63], v[156:159], v[92:95], v[60:63]
    v_cmp_eq_u32 vcc, 0, v11
    v_lshrrev_b32 v11, 16, v204
    ds_read_b64_tr_b16 v[64:65], v214 offset:16384
    ds_read_b64_tr_b16 v[66:67], v214 offset:18432
    s_waitcnt lgkmcnt(8)
    v_mfma_f32_16x16x32_bf16 v[32:35], v[152:155], v[80:83], v[32:35]
    v_and_b32 v12, 0xffff0000, v204
    v_mfma_f32_16x16x32_bf16 v[48:51], v[156:159], v[80:83], v[48:51]
    v_cndmask_b32 v13, v12, v11, vcc
    v_lshlrev_b32 v204, 16, v204
    ds_read_b64_tr_b16 v[68:69], v215 offset:16384
    ds_read_b64_tr_b16 v[70:71], v215 offset:18432
    s_waitcnt lgkmcnt(8)
    v_mfma_f32_16x16x32_bf16 v[36:39], v[152:155], v[84:87], v[36:39]
    v_lshrrev_b32 v11, 16, v205
    v_mfma_f32_16x16x32_bf16 v[52:55], v[156:159], v[84:87], v[52:55]
    v_and_b32 v12, 0xffff0000, v205
    v_cndmask_b32 v14, v12, v11, vcc
    s_waitcnt vmcnt(6)
    ds_read_b64_tr_b16 v[88:89], v216 offset:20480
    ds_read_b64_tr_b16 v[90:91], v216 offset:22528
    s_waitcnt lgkmcnt(8)
    v_mfma_f32_16x16x32_bf16 v[40:43], v[160:163], v[72:75], v[40:43]
    v_lshlrev_b32 v205, 16, v205
    v_mfma_f32_16x16x32_bf16 v[56:59], v[164:167], v[72:75], v[56:59]
    v_cmp_eq_u32 vcc, 0, v2
    ds_read_b64_tr_b16 v[92:93], v217 offset:20480
    ds_read_b64_tr_b16 v[94:95], v217 offset:22528
    s_waitcnt lgkmcnt(8)
    v_mfma_f32_16x16x32_bf16 v[44:47], v[160:163], v[76:79], v[44:47]
    v_cndmask_b32 v96, 0, v13, vcc
    v_mfma_f32_16x16x32_bf16 v[60:63], v[164:167], v[76:79], v[60:63]
    v_cmp_eq_u32 vcc, 1, v2
    ds_read_b64_tr_b16 v[80:81], v214 offset:20480
    ds_read_b64_tr_b16 v[82:83], v214 offset:22528
    s_waitcnt lgkmcnt(8)
    v_mfma_f32_16x16x32_bf16 v[32:35], v[160:163], v[64:67], v[32:35]
    v_cndmask_b32 v97, 0, v13, vcc
    v_mfma_f32_16x16x32_bf16 v[48:51], v[164:167], v[64:67], v[48:51]
    v_cmp_eq_u32 vcc, 2, v2
    ds_read_b64_tr_b16 v[84:85], v215 offset:20480
    ds_read_b64_tr_b16 v[86:87], v215 offset:22528
    s_waitcnt lgkmcnt(8)
    v_mfma_f32_16x16x32_bf16 v[36:39], v[160:163], v[68:71], v[36:39]
    v_cndmask_b32 v98, 0, v13, vcc
    v_mfma_f32_16x16x32_bf16 v[52:55], v[164:167], v[68:71], v[52:55]
    v_cmp_eq_u32 vcc, 3, v2
    s_waitcnt vmcnt(4)
    ds_read_b64_tr_b16 v[72:73], v216 offset:24576
    ds_read_b64_tr_b16 v[74:75], v216 offset:26624
    s_waitcnt lgkmcnt(8)
    v_mfma_f32_16x16x32_bf16 v[40:43], v[168:171], v[88:91], v[40:43]
    v_cndmask_b32 v99, 0, v13, vcc
    v_mfma_f32_16x16x32_bf16 v[56:59], v[172:175], v[88:91], v[56:59]
    v_cmp_eq_u32 vcc, -8, v2
    ds_read_b64_tr_b16 v[76:77], v217 offset:24576
    ds_read_b64_tr_b16 v[78:79], v217 offset:26624
    s_waitcnt lgkmcnt(8)
    v_mfma_f32_16x16x32_bf16 v[44:47], v[168:171], v[92:95], v[44:47]
    v_cndmask_b32 v100, 0, v14, vcc
    v_mfma_f32_16x16x32_bf16 v[60:63], v[172:175], v[92:95], v[60:63]
    v_cmp_eq_u32 vcc, -7, v2
    ds_read_b64_tr_b16 v[64:65], v214 offset:24576
    ds_read_b64_tr_b16 v[66:67], v214 offset:26624
    s_waitcnt lgkmcnt(8)
    v_mfma_f32_16x16x32_bf16 v[32:35], v[168:171], v[80:83], v[32:35]
    v_cndmask_b32 v101, 0, v14, vcc
    v_mfma_f32_16x16x32_bf16 v[48:51], v[172:175], v[80:83], v[48:51]
    v_cmp_eq_u32 vcc, -6, v2
    ds_read_b64_tr_b16 v[68:69], v215 offset:24576
    ds_read_b64_tr_b16 v[70:71], v215 offset:26624
    s_waitcnt lgkmcnt(8)
    v_mfma_f32_16x16x32_bf16 v[36:39], v[168:171], v[84:87], v[36:39]
    v_cndmask_b32 v102, 0, v14, vcc
    v_mfma_f32_16x16x32_bf16 v[52:55], v[172:175], v[84:87], v[52:55]
    v_cmp_eq_u32 vcc, -5, v2
    s_waitcnt vmcnt(2)
    ds_read_b64_tr_b16 v[88:89], v216 offset:28672
    ds_read_b64_tr_b16 v[90:91], v216 offset:30720
    s_waitcnt lgkmcnt(8)
    v_mfma_f32_16x16x32_bf16 v[40:43], v[176:179], v[72:75], v[40:43]
    v_cndmask_b32 v103, 0, v14, vcc
    v_mfma_f32_16x16x32_bf16 v[56:59], v[180:183], v[72:75], v[56:59]
    ds_read_b64_tr_b16 v[92:93], v217 offset:28672
    ds_read_b64_tr_b16 v[94:95], v217 offset:30720
    s_waitcnt lgkmcnt(8)
    v_mfma_f32_16x16x32_bf16 v[44:47], v[176:179], v[76:79], v[44:47]
    v_mfma_f32_16x16x32_bf16 v[60:63], v[180:183], v[76:79], v[60:63]
    ds_read_b64_tr_b16 v[80:81], v214 offset:28672
    ds_read_b64_tr_b16 v[82:83], v214 offset:30720
    s_waitcnt lgkmcnt(8)
    v_mfma_f32_16x16x32_bf16 v[32:35], v[176:179], v[64:67], v[32:35]
    v_mfma_f32_16x16x32_bf16 v[48:51], v[180:183], v[64:67], v[48:51]
    ds_read_b64_tr_b16 v[84:85], v215 offset:28672
    ds_read_b64_tr_b16 v[86:87], v215 offset:30720
    s_waitcnt lgkmcnt(8)
    v_mfma_f32_16x16x32_bf16 v[36:39], v[176:179], v[68:71], v[36:39]
    v_mfma_f32_16x16x32_bf16 v[52:55], v[180:183], v[68:71], v[52:55]
    s_waitcnt vmcnt(0)
    s_waitcnt lgkmcnt(6)
    v_mfma_f32_16x16x32_bf16 v[40:43], v[184:187], v[88:91], v[40:43]
    v_mfma_f32_16x16x32_bf16 v[56:59], v[188:191], v[88:91], v[56:59]
    s_waitcnt lgkmcnt(4)
    v_mfma_f32_16x16x32_bf16 v[44:47], v[184:187], v[92:95], v[44:47]
    v_mfma_f32_16x16x32_bf16 v[60:63], v[188:191], v[92:95], v[60:63]
    s_waitcnt lgkmcnt(2)
    v_mfma_f32_16x16x32_bf16 v[32:35], v[184:187], v[80:83], v[32:35]
    v_mfma_f32_16x16x32_bf16 v[48:51], v[188:191], v[80:83], v[48:51]
    s_waitcnt lgkmcnt(0)
    v_mfma_f32_16x16x32_bf16 v[36:39], v[184:187], v[84:87], v[36:39]
    v_mfma_f32_16x16x32_bf16 v[52:55], v[188:191], v[84:87], v[52:55]
    s_cmp_lg_u32 s61, 0
    s_cbranch_scc1 L_fB_1010
    v_mfma_f32_16x16x32_bf16 v[32:35], v[96:99], v[192:195], v[32:35]
    v_mfma_f32_16x16x32_bf16 v[36:39], v[96:99], v[196:199], v[36:39]
    v_mfma_f32_16x16x32_bf16 v[48:51], v[100:103], v[192:195], v[48:51]
    v_mfma_f32_16x16x32_bf16 v[52:55], v[100:103], v[196:199], v[52:55]
    ds_write_b128 v218, v[40:43] offset:2048
    ds_write_b128 v218, v[44:47] offset:3072
    ds_write_b128 v218, v[56:59] offset:6144
    ds_write_b128 v218, v[60:63] offset:7168
    s_nop 0
    ds_write_b128 v218, v[32:35] offset:0
    ds_write_b128 v218, v[36:39] offset:1024
    ds_write_b128 v218, v[48:51] offset:4096
    ds_write_b128 v218, v[52:55] offset:5120
    s_waitcnt lgkmcnt(0)
    s_barrier
    s_endpgm
L_fB_1010:
    v_mfma_f32_16x16x32_bf16 v[104:107], v[192:195], v[96:99], 0
    ds_write_b128 v218, v[40:43] offset:0
    v_mfma_f32_16x16x32_bf16 v[108:111], v[192:195], v[100:103], 0
    ds_write_b128 v218, v[44:47] offset:1024
    v_mfma_f32_16x16x32_bf16 v[112:115], v[196:199], v[96:99], 0
    ds_write_b128 v218, v[56:59] offset:2048
    v_mfma_f32_16x16x32_bf16 v[116:119], v[196:199], v[100:103], 0
    ds_write_b128 v218, v[60:63] offset:3072
    v_xor_b32 v7, 0x4000, v218
    s_add_u32 s71, s70, 0x8000
    s_waitcnt lgkmcnt(0)
    s_barrier
    ds_read_b128 v[64:67], v7 offset:0
    ds_read_b128 v[68:71], v7 offset:1024
    ds_read_b128 v[72:75], v7 offset:2048
    ds_read_b128 v[76:79], v7 offset:3072
    s_waitcnt lgkmcnt(3)
    v_add_f32 v64, v64, v32
    v_add_f32 v65, v65, v33
    v_add_f32 v66, v66, v34
    v_add_f32 v67, v67, v35
    v_fmac_f32 v104, v204, v64
    v_fmac_f32 v105, v204, v65
    v_fmac_f32 v106, v204, v66
    v_fmac_f32 v107, v204, v67
    buffer_store_dwordx4 v[104:107], v213, s[56:59], s70 offen offset:0 sc0 sc1
    s_waitcnt lgkmcnt(2)
    v_add_f32 v68, v68, v36
    v_add_f32 v69, v69, v37
    v_add_f32 v70, v70, v38
    v_add_f32 v71, v71, v39
    v_fmac_f32 v108, v205, v68
    v_fmac_f32 v109, v205, v69
    v_fmac_f32 v110, v205, v70
    v_fmac_f32 v111, v205, v71
    buffer_store_dwordx4 v[108:111], v213, s[56:59], s71 offen offset:0 sc0 sc1
    s_waitcnt lgkmcnt(1)
    v_add_f32 v72, v72, v48
    v_add_f32 v73, v73, v49
    v_add_f32 v74, v74, v50
    v_add_f32 v75, v75, v51
    v_fmac_f32 v112, v204, v72
    v_fmac_f32 v113, v204, v73
    v_fmac_f32 v114, v204, v74
    v_fmac_f32 v115, v204, v75
    buffer_store_dwordx4 v[112:115], v213, s[56:59], s70 offen offset:64 sc0 sc1
    s_waitcnt lgkmcnt(0)
    v_add_f32 v76, v76, v52
    v_add_f32 v77, v77, v53
    v_add_f32 v78, v78, v54
    v_add_f32 v79, v79, v55
    v_fmac_f32 v116, v205, v76
    v_fmac_f32 v117, v205, v77
    v_fmac_f32 v118, v205, v78
    v_fmac_f32 v119, v205, v79
    buffer_store_dwordx4 v[116:119], v213, s[56:59], s71 offen offset:64 sc0 sc1
L_end2_1001:
    s_endpgm
.section .rodata,"a"
.p2align 6
.amdhsa_kernel mix_a_kernel
  .amdhsa_next_free_vgpr 256
  .amdhsa_next_free_sgpr 102
  .amdhsa_accum_offset 256
  .amdhsa_group_segment_fixed_size 0
  .amdhsa_kernarg_size 176
  .amdhsa_user_sgpr_count 2
  .amdhsa_user_sgpr_kernarg_segment_ptr 1
  .amdhsa_system_sgpr_workgroup_id_x 1
.end_amdhsa_kernel
.p2align 6
.amdhsa_kernel mix_b_kernel
  .amdhsa_next_free_vgpr 256
  .amdhsa_next_free_sgpr 102
  .amdhsa_accum_offset 256
  .amdhsa_group_segment_fixed_size 0
  .amdhsa_kernarg_size 176
  .amdhsa_user_sgpr_count 2
  .amdhsa_user_sgpr_kernarg_segment_ptr 1
  .amdhsa_system_sgpr_workgroup_id_x 1
.end_amdhsa_kernel
```
